```python
import torch

def _softmax(x, axis=-1):
    return torch.softmax(x, dim=axis)
def _gelu(x):
    return torch.nn.functional.gelu(x, approximate="tanh")
def _silu(x):
    return torch.nn.functional.silu(x)
def _sigmoid(x):
    return torch.sigmoid(x)
def _layernorm(x, axis=-1, eps=1e-5):
    m = x.mean(dim=axis, keepdim=True)
    v = x.var(dim=axis, keepdim=True, unbiased=False)
    return (x - m) / torch.sqrt(v + eps)
def _scatter_add(tgt, idx, src, axis=0):
    return tgt.clone().index_add_(axis, idx, src)
def _segment_sum(src, seg, n):
    out = torch.zeros((n,) + src.shape[1:], dtype=src.dtype)
    return out.index_add_(0, seg, src)
def _pad(x, pw):
    flat = tuple(v for pair in reversed(pw) for v in pair)
    return torch.nn.functional.pad(x, flat)

kernel_name = 'concat_heads__softmax_full_mha__sliding_block__prompt'

def setup_inputs():

    _w = (lambda a: (lambda t: t.to(torch.bfloat16) if t.is_floating_point() else t)(torch.as_tensor(a)))
    def _A_setup():
        B, S, D = 1, 2048, 512
        return {
            "x": _w((lambda *s: torch.randn(*s, dtype=torch.bfloat16) * 0.2)(B, S, D)),
            "wqkv": _w((lambda *s: torch.randn(*s, dtype=torch.bfloat16) * 0.4)(D, 3 * D)),
            "wo": _w((lambda *s: torch.randn(*s, dtype=torch.bfloat16) * 0.1)(D, D)),
        }
    _A_in = _A_setup()

    def _B_setup():
        B, S, D = 1, 2048, 512
        return {
            "x": _w((lambda *s: torch.randn(*s, dtype=torch.bfloat16) * 0.4)(B, S, D)),
            "wqkv": _w((lambda *s: torch.randn(*s, dtype=torch.bfloat16) * 0.4)(D, 3 * D)),
            "wo": _w((lambda *s: torch.randn(*s, dtype=torch.bfloat16) * 0.05)(D, D)),
        }
    _B_in = _B_setup()

    return {
        "A_x": _A_in["x"],
        "A_wqkv": _A_in["wqkv"],
        "A_wo": _A_in["wo"],
        "B_x": _B_in["x"],
        "B_wqkv": _B_in["wqkv"],
        "B_wo": _B_in["wo"],
    }

def reference(A_x, A_wqkv, A_wo, B_x, B_wqkv, B_wo):
    def _A_ref(x, wqkv, wo):
        B, S, D = x.shape
        H = 32; Dh = D // H
        qkv = (lambda x, *d: x.permute(*d))((x @ wqkv).reshape(B, S, 3, H, Dh), 2, 0, 3, 1, 4)
        q, k, v = qkv[0], qkv[1], qkv[2]
        scale = Dh ** -0.5
        scores = torch.einsum("bhqd,bhkd->bhqk", q, k) * scale
        p = _softmax(scores, axis=-1)
        o = torch.einsum("bhqk,bhkd->bhqd", p, v)
        return (lambda x, *d: x.permute(*d))(o, 0, 2, 1, 3).reshape(B, S, D) @ wo

    def _B_ref(x, wqkv, wo):
        B, S, D = x.shape
        H = 32; Dh = D // H; W = 256
        qkv = (lambda x, *d: x.permute(*d))((x @ wqkv).reshape(B, S, 3, H, Dh), 2, 0, 3, 1, 4)
        q, k, v = qkv[0], qkv[1], qkv[2]
        scores = torch.einsum("bhqd,bhkd->bhqk", q, k) * (Dh ** -0.5)
        idx = torch.arange(S)
        mask = (idx[:, None] - idx[None, :] >= 0) & (idx[:, None] - idx[None, :] < W)
        scores = torch.where(mask[None, None], scores, -1e9)
        p = _softmax(scores, axis=-1)
        o = torch.einsum("bhqk,bhkd->bhqd", p, v)
        return (lambda x, *d: x.permute(*d))(o, 0, 2, 1, 3).reshape(B, S, D) @ wo

    a = _A_ref(A_x, A_wqkv, A_wo)
    b = _B_ref(B_x, B_wqkv, B_wo)
    return torch.concatenate([a, b], axis=-1)
```

```asm
; @launch grid=(256,1,1) block=(512,1,1) lds=163840
.amdgcn_target "amdgcn-amd-amdhsa--gfx950"
.text
.globl concat_heads__softmax_full_mha__sliding_block__prompt_kernel
.p2align 8
.type concat_heads__softmax_full_mha__sliding_block__prompt_kernel,@function
concat_heads__softmax_full_mha__sliding_block__prompt_kernel:
  s_cmp_ge_u32 s2, 256
  s_cbranch_scc1 Lfa_end
  s_load_dwordx4 s[36:39], s[0:1], 0
  s_load_dwordx2 s[34:35], s[0:1], 24
  s_load_dwordx2 s[42:43], s[0:1], 32
  s_load_dwordx4 s[44:47], s[0:1], 56
  v_and_b32 v1, 63, v0
  v_lshrrev_b32 v2, 6, v0
  s_and_b32 s30, s2, 31
  v_readfirstlane_b32 s3, v2
  s_lshr_b32 s31, s2, 5
  s_lshr_b32 s48, s2, 3
  s_and_b32 s49, s2, 1
  s_lshl_b32 s49, s49, 2
  s_and_b32 s50, s48, 3
  s_add_u32 s32, s49, s50
  s_bfe_u32 s49, s2, 0x20001
  s_lshl_b32 s49, s49, 3
  s_lshr_b32 s50, s48, 2
  s_add_u32 s33, s49, s50
  s_and_b32 s29, s32, 3
  s_lshl_b32 s29, s29, 1
  s_add_u32 s29, s29, s33
  s_and_b32 s29, s29, 7
  s_cmp_lt_u32 s3, 4
  s_cbranch_scc1 Lfa_compute
  s_sub_u32 s48, s3, 4
  v_lshrrev_b32 v2, 3, v1
  v_lshlrev_b32 v2, 10, v2
  v_and_b32 v3, 7, v1
  v_lshrrev_b32 v6, 4, v1
  v_xor_b32 v3, v3, v6
  v_lshlrev_b32 v3, 4, v3
  v_add_u32 v4, v2, v3
  v_xor_b32 v5, 64, v4
  s_lshl_b32 s50, s33, 6
  s_lshl_b32 s49, s48, 4
  s_add_u32 s50, s50, s49
  s_lshl_b32 s50, s50, 10
  s_lshl_b32 s51, s48, 11
  s_mul_i32 s52, s48, 49152
  s_lshl_b32 s49, s32, 7
  s_add_u32 s52, s52, s49
  s_mul_i32 s53, s48, 6144
  s_add_u32 s53, s53, 8192
  s_movk_i32 s49, 171
  s_movk_i32 s55, 3072
  v_add_u32 v2, 0, v1
  v_mul_lo_u32 v3, v2, s49
  v_lshrrev_b32 v3, 12, v3
  v_mul_u32_u24 v9, 24, v3
  v_sub_u32 v9, v2, v9
  v_bfe_u32 v10, v3, 1, 1
  v_lshlrev_b32 v10, 2, v10
  v_xor_b32 v9, v9, v10
  v_mul_lo_u32 v3, v3, s55
  v_lshrrev_b32 v10, 3, v9
  v_lshlrev_b32 v10, 10, v10
  v_add_u32 v3, v3, v10
  v_and_b32 v9, 7, v9
  v_lshlrev_b32 v9, 4, v9
  v_add_u32 v6, v3, v9
  v_add_u32 v2, 64, v1
  v_mul_lo_u32 v3, v2, s49
  v_lshrrev_b32 v3, 12, v3
  v_mul_u32_u24 v9, 24, v3
  v_sub_u32 v9, v2, v9
  v_bfe_u32 v10, v3, 1, 1
  v_lshlrev_b32 v10, 2, v10
  v_xor_b32 v9, v9, v10
  v_mul_lo_u32 v3, v3, s55
  v_lshrrev_b32 v10, 3, v9
  v_lshlrev_b32 v10, 10, v10
  v_add_u32 v3, v3, v10
  v_and_b32 v9, 7, v9
  v_lshlrev_b32 v9, 4, v9
  v_add_u32 v7, v3, v9
  v_add_u32 v2, 128, v1
  v_mul_lo_u32 v3, v2, s49
  v_lshrrev_b32 v3, 12, v3
  v_mul_u32_u24 v9, 24, v3
  v_sub_u32 v9, v2, v9
  v_bfe_u32 v10, v3, 1, 1
  v_lshlrev_b32 v10, 2, v10
  v_xor_b32 v9, v9, v10
  v_mul_lo_u32 v3, v3, s55
  v_lshrrev_b32 v10, 3, v9
  v_lshlrev_b32 v10, 10, v10
  v_add_u32 v3, v3, v10
  v_and_b32 v9, 7, v9
  v_lshlrev_b32 v9, 4, v9
  v_add_u32 v8, v3, v9
  s_waitcnt lgkmcnt(0)
  s_mov_b32 s16, s36
  s_and_b32 s17, s37, 0xffff
  s_mov_b32 s18, 2097152
  s_mov_b32 s19, 0x00020000
  s_mov_b32 s20, s38
  s_and_b32 s21, s39, 0xffff
  s_mov_b32 s22, 1572864
  s_mov_b32 s23, 0x00020000
  s_add_u32 s58, s29, 0
  s_and_b32 s58, s58, 7
  s_lshl_b32 s59, s58, 7
  s_add_u32 s59, s59, s50
  s_mul_i32 s58, s58, 196608
  s_add_u32 s58, s58, s52
  s_add_u32 m0, s51, 0
  s_add_u32 s54, s59, 0
  buffer_load_dwordx4 v4, s[16:19], s54 offen lds
  s_add_u32 m0, s51, 1024
  s_add_u32 s54, s59, 8192
  buffer_load_dwordx4 v5, s[16:19], s54 offen lds
  s_add_u32 m0, s53, 0
  s_add_u32 s54, s58, 0
  buffer_load_dwordx4 v6, s[20:23], s54 offen lds
  s_add_u32 m0, s53, 1024
  s_add_u32 s54, s58, 0
  buffer_load_dwordx4 v7, s[20:23], s54 offen lds
  s_add_u32 m0, s53, 2048
  s_add_u32 s54, s58, 0
  buffer_load_dwordx4 v8, s[20:23], s54 offen lds
  s_add_u32 m0, s53, 3072
  s_add_u32 s54, s58, 24576
  buffer_load_dwordx4 v6, s[20:23], s54 offen lds
  s_add_u32 m0, s53, 4096
  s_add_u32 s54, s58, 24576
  buffer_load_dwordx4 v7, s[20:23], s54 offen lds
  s_add_u32 m0, s53, 5120
  s_add_u32 s54, s58, 24576
  buffer_load_dwordx4 v8, s[20:23], s54 offen lds
  s_add_u32 s58, s29, 1
  s_and_b32 s58, s58, 7
  s_lshl_b32 s59, s58, 7
  s_add_u32 s59, s59, s50
  s_mul_i32 s58, s58, 196608
  s_add_u32 s58, s58, s52
  s_add_u32 m0, s51, 32768
  s_add_u32 s54, s59, 0
  buffer_load_dwordx4 v4, s[16:19], s54 offen lds
  s_add_u32 m0, s51, 33792
  s_add_u32 s54, s59, 8192
  buffer_load_dwordx4 v5, s[16:19], s54 offen lds
  s_add_u32 m0, s53, 32768
  s_add_u32 s54, s58, 0
  buffer_load_dwordx4 v6, s[20:23], s54 offen lds
  s_add_u32 m0, s53, 33792
  s_add_u32 s54, s58, 0
  buffer_load_dwordx4 v7, s[20:23], s54 offen lds
  s_add_u32 m0, s53, 34816
  s_add_u32 s54, s58, 0
  buffer_load_dwordx4 v8, s[20:23], s54 offen lds
  s_add_u32 m0, s53, 35840
  s_add_u32 s54, s58, 24576
  buffer_load_dwordx4 v6, s[20:23], s54 offen lds
  s_add_u32 m0, s53, 36864
  s_add_u32 s54, s58, 24576
  buffer_load_dwordx4 v7, s[20:23], s54 offen lds
  s_add_u32 m0, s53, 37888
  s_add_u32 s54, s58, 24576
  buffer_load_dwordx4 v8, s[20:23], s54 offen lds
  s_mov_b32 s8, s34
  s_and_b32 s9, s35, 0xffff
  s_mov_b32 s10, 2097152
  s_mov_b32 s11, 0x00020000
  s_mov_b32 s12, s42
  s_and_b32 s13, s43, 0xffff
  s_mov_b32 s14, 1572864
  s_mov_b32 s15, 0x00020000
  s_mov_b32 s4, s46
  s_and_b32 s5, s47, 0xffff
  s_mov_b32 s6, 17825792
  s_mov_b32 s7, 0x00020000
  s_mov_b32 s24, s44
  s_and_b32 s25, s45, 0xffff
  s_mov_b32 s26, 256
  s_mov_b32 s27, 0x00020000
  s_cmp_eq_u32 s2, 0
  s_cselect_b32 s49, s48, 1
  s_cmp_eq_u32 s49, 0
  s_cbranch_scc0 Lfa_nononce
  s_memrealtime s[56:57]
  s_waitcnt lgkmcnt(0)
  s_or_b32 s56, s56, 1
  v_mov_b32 v10, s56
  v_mov_b32 v11, 0
  buffer_store_dword v10, v11, s[24:27], 0 offen sc1
Lfa_nononce:
  s_add_u32 s58, s29, 0
  s_and_b32 s58, s58, 7
  s_lshl_b32 s59, s58, 7
  s_add_u32 s59, s59, s50
  s_mul_i32 s58, s58, 196608
  s_add_u32 s58, s58, s52
  s_add_u32 m0, s51, 131072
  s_add_u32 s54, s59, 0
  buffer_load_dwordx4 v4, s[8:11], s54 offen lds
  s_add_u32 m0, s51, 132096
  s_add_u32 s54, s59, 8192
  buffer_load_dwordx4 v5, s[8:11], s54 offen lds
  s_add_u32 m0, s53, 131072
  s_add_u32 s54, s58, 0
  buffer_load_dwordx4 v6, s[12:15], s54 offen lds
  s_add_u32 m0, s53, 132096
  s_add_u32 s54, s58, 0
  buffer_load_dwordx4 v7, s[12:15], s54 offen lds
  s_add_u32 m0, s53, 133120
  s_add_u32 s54, s58, 0
  buffer_load_dwordx4 v8, s[12:15], s54 offen lds
  s_add_u32 m0, s53, 134144
  s_add_u32 s54, s58, 24576
  buffer_load_dwordx4 v6, s[12:15], s54 offen lds
  s_add_u32 m0, s53, 135168
  s_add_u32 s54, s58, 24576
  buffer_load_dwordx4 v7, s[12:15], s54 offen lds
  s_add_u32 m0, s53, 136192
  s_add_u32 s54, s58, 24576
  buffer_load_dwordx4 v8, s[12:15], s54 offen lds
  v_lshlrev_b32 v247, 4, v1
  v_lshrrev_b32 v250, 5, v1
  v_lshlrev_b32 v3, 8, v250
  v_and_b32 v251, 15, v1
  v_lshlrev_b32 v251, 4, v251
  v_add_u32 v3, v3, v251
  v_add_u32 v3, 1024, v3
  v_and_b32 v251, 27, v1
  v_cmp_eq_u32 vcc, 16, v251
  v_mov_b32 v252, 0x3f803f80
  v_mov_b32 v253, 0
  s_nop 0
  v_cndmask_b32 v160, v253, v252, vcc
  v_cndmask_b32 v161, v253, v252, vcc
  v_cndmask_b32 v162, v253, v252, vcc
  v_cndmask_b32 v163, v253, v252, vcc
  v_cndmask_b32 v164, v253, v252, vcc
  v_cndmask_b32 v165, v253, v252, vcc
  v_cndmask_b32 v166, v253, v252, vcc
  v_cndmask_b32 v167, v253, v252, vcc
  v_cndmask_b32 v168, v253, v252, vcc
  v_cndmask_b32 v169, v253, v252, vcc
  v_cndmask_b32 v170, v253, v252, vcc
  v_cndmask_b32 v171, v253, v252, vcc
  v_cndmask_b32 v172, v253, v252, vcc
  v_cndmask_b32 v173, v253, v252, vcc
  v_cndmask_b32 v174, v253, v252, vcc
  v_cndmask_b32 v175, v253, v252, vcc
  v_and_b32 v251, 31, v1
  v_lshlrev_b32 v250, 2, v250
  v_sub_u32 v251, v251, v250
  v_mov_b32 v252, 0xff800000
  v_cmp_le_i32 s[62:63], 0, v251
  v_cmp_le_i32 s[64:65], 1, v251
  v_cmp_le_i32 s[66:67], 2, v251
  v_cmp_le_i32 s[68:69], 3, v251
  s_nop 1
  v_cndmask_b32 v212, v252, v253, s[62:63]
  v_cndmask_b32 v228, v253, v252, s[62:63]
  v_cndmask_b32 v213, v252, v253, s[64:65]
  v_cndmask_b32 v229, v253, v252, s[64:65]
  v_cndmask_b32 v214, v252, v253, s[66:67]
  v_cndmask_b32 v230, v253, v252, s[66:67]
  v_cndmask_b32 v215, v252, v253, s[68:69]
  v_cndmask_b32 v231, v253, v252, s[68:69]
  v_cmp_le_i32 s[62:63], 8, v251
  v_cmp_le_i32 s[64:65], 9, v251
  v_cmp_le_i32 s[66:67], 10, v251
  v_cmp_le_i32 s[68:69], 11, v251
  s_nop 1
  v_cndmask_b32 v216, v252, v253, s[62:63]
  v_cndmask_b32 v232, v253, v252, s[62:63]
  v_cndmask_b32 v217, v252, v253, s[64:65]
  v_cndmask_b32 v233, v253, v252, s[64:65]
  v_cndmask_b32 v218, v252, v253, s[66:67]
  v_cndmask_b32 v234, v253, v252, s[66:67]
  v_cndmask_b32 v219, v252, v253, s[68:69]
  v_cndmask_b32 v235, v253, v252, s[68:69]
  v_cmp_le_i32 s[62:63], 16, v251
  v_cmp_le_i32 s[64:65], 17, v251
  v_cmp_le_i32 s[66:67], 18, v251
  v_cmp_le_i32 s[68:69], 19, v251
  s_nop 1
  v_cndmask_b32 v220, v252, v253, s[62:63]
  v_cndmask_b32 v236, v253, v252, s[62:63]
  v_cndmask_b32 v221, v252, v253, s[64:65]
  v_cndmask_b32 v237, v253, v252, s[64:65]
  v_cndmask_b32 v222, v252, v253, s[66:67]
  v_cndmask_b32 v238, v253, v252, s[66:67]
  v_cndmask_b32 v223, v252, v253, s[68:69]
  v_cndmask_b32 v239, v253, v252, s[68:69]
  v_cmp_le_i32 s[62:63], 24, v251
  v_cmp_le_i32 s[64:65], 25, v251
  v_cmp_le_i32 s[66:67], 26, v251
  v_cmp_le_i32 s[68:69], 27, v251
  s_nop 1
  v_cndmask_b32 v224, v252, v253, s[62:63]
  v_cndmask_b32 v240, v253, v252, s[62:63]
  v_cndmask_b32 v225, v252, v253, s[64:65]
  v_cndmask_b32 v241, v253, v252, s[64:65]
  v_cndmask_b32 v226, v252, v253, s[66:67]
  v_cndmask_b32 v242, v253, v252, s[66:67]
  v_cndmask_b32 v227, v252, v253, s[68:69]
  v_cndmask_b32 v243, v253, v252, s[68:69]
  s_lshr_b32 s70, s3, 2
  s_lshl_b32 s71, s70, 14
  s_add_u32 s72, s71, 131072
  v_add_u32 v254, s71, v247
  v_add_u32 v255, s71, v3
  v_add_u32 v244, s72, v247
  v_add_u32 v245, s72, v3
  s_mov_b32 s73, 0
  s_mov_b32 s40, 0x0000ffff
  s_mov_b32 s41, 0x0000ffff
  s_lshr_b32 s56, s30, 2
  s_lshl_b32 s56, s56, 12
  s_add_u32 s56, s56, 16777216
  v_and_b32 v12, 31, v1
  v_lshlrev_b32 v12, 7, v12
  v_add_u32 v12, s56, v12
  s_lshl_b32 s56, s32, 5
  s_add_u32 s56, s56, s33
  s_lshl_b32 s74, s56, 7
  v_and_b32 v2, 7, v1
  s_lshl_b32 s49, s31, 2
  s_sub_u32 s49, s49, 4
  v_add_u32 v2, s49, v2
  v_max_i32 v2, 0, v2
  s_lshr_b32 s49, s30, 2
  s_lshl_b32 s49, s49, 5
  v_add_u32 v2, s49, v2
  v_lshlrev_b32 v2, 7, v2
  v_add_u32 v2, 16842752, v2
  v_mov_b32 v11, 0
  s_waitcnt vmcnt(16)
  s_barrier
  buffer_load_dword v10, v11, s[24:27], 0 offen sc1
  s_add_u32 s58, s29, 2
  s_and_b32 s58, s58, 7
  s_lshl_b32 s59, s58, 7
  s_add_u32 s59, s59, s50
  s_mul_i32 s58, s58, 196608
  s_add_u32 s58, s58, s52
  s_add_u32 m0, s51, 65536
  s_add_u32 s54, s59, 0
  buffer_load_dwordx4 v4, s[16:19], s54 offen lds
  s_add_u32 m0, s51, 66560
  s_add_u32 s54, s59, 8192
  buffer_load_dwordx4 v5, s[16:19], s54 offen lds
  s_add_u32 m0, s53, 65536
  s_add_u32 s54, s58, 0
  buffer_load_dwordx4 v6, s[20:23], s54 offen lds
  s_add_u32 m0, s53, 66560
  s_add_u32 s54, s58, 0
  buffer_load_dwordx4 v7, s[20:23], s54 offen lds
  s_add_u32 m0, s53, 67584
  s_add_u32 s54, s58, 0
  buffer_load_dwordx4 v8, s[20:23], s54 offen lds
  s_add_u32 m0, s53, 68608
  s_add_u32 s54, s58, 24576
  buffer_load_dwordx4 v6, s[20:23], s54 offen lds
  s_add_u32 m0, s53, 69632
  s_add_u32 s54, s58, 24576
  buffer_load_dwordx4 v7, s[20:23], s54 offen lds
  s_add_u32 m0, s53, 70656
  s_add_u32 s54, s58, 24576
  buffer_load_dwordx4 v8, s[20:23], s54 offen lds
  s_waitcnt vmcnt(17)
  s_barrier
  s_add_u32 s58, s29, 3
  s_and_b32 s58, s58, 7
  s_lshl_b32 s59, s58, 7
  s_add_u32 s59, s59, s50
  s_mul_i32 s58, s58, 196608
  s_add_u32 s58, s58, s52
  s_add_u32 m0, s51, 98304
  s_add_u32 s54, s59, 0
  buffer_load_dwordx4 v4, s[16:19], s54 offen lds
  s_add_u32 m0, s51, 99328
  s_add_u32 s54, s59, 8192
  buffer_load_dwordx4 v5, s[16:19], s54 offen lds
  s_add_u32 m0, s53, 98304
  s_add_u32 s54, s58, 0
  buffer_load_dwordx4 v6, s[20:23], s54 offen lds
  s_add_u32 m0, s53, 99328
  s_add_u32 s54, s58, 0
  buffer_load_dwordx4 v7, s[20:23], s54 offen lds
  s_add_u32 m0, s53, 100352
  s_add_u32 s54, s58, 0
  buffer_load_dwordx4 v8, s[20:23], s54 offen lds
  s_add_u32 m0, s53, 101376
  s_add_u32 s54, s58, 24576
  buffer_load_dwordx4 v6, s[20:23], s54 offen lds
  s_add_u32 m0, s53, 102400
  s_add_u32 s54, s58, 24576
  buffer_load_dwordx4 v7, s[20:23], s54 offen lds
  s_add_u32 m0, s53, 103424
  s_add_u32 s54, s58, 24576
  buffer_load_dwordx4 v8, s[20:23], s54 offen lds
  s_waitcnt vmcnt(8)
  s_barrier
  s_add_u32 s58, s29, 4
  s_and_b32 s58, s58, 7
  s_lshl_b32 s59, s58, 7
  s_add_u32 s59, s59, s50
  s_mul_i32 s58, s58, 196608
  s_add_u32 s58, s58, s52
  s_add_u32 m0, s51, 0
  s_add_u32 s54, s59, 0
  buffer_load_dwordx4 v4, s[16:19], s54 offen lds
  s_add_u32 m0, s51, 1024
  s_add_u32 s54, s59, 8192
  buffer_load_dwordx4 v5, s[16:19], s54 offen lds
  s_add_u32 m0, s53, 0
  s_add_u32 s54, s58, 0
  buffer_load_dwordx4 v6, s[20:23], s54 offen lds
  s_add_u32 m0, s53, 1024
  s_add_u32 s54, s58, 0
  buffer_load_dwordx4 v7, s[20:23], s54 offen lds
  s_add_u32 m0, s53, 2048
  s_add_u32 s54, s58, 0
  buffer_load_dwordx4 v8, s[20:23], s54 offen lds
  s_add_u32 m0, s53, 3072
  s_add_u32 s54, s58, 24576
  buffer_load_dwordx4 v6, s[20:23], s54 offen lds
  s_add_u32 m0, s53, 4096
  s_add_u32 s54, s58, 24576
  buffer_load_dwordx4 v7, s[20:23], s54 offen lds
  s_add_u32 m0, s53, 5120
  s_add_u32 s54, s58, 24576
  buffer_load_dwordx4 v8, s[20:23], s54 offen lds
  s_waitcnt vmcnt(8)
  s_mov_b32 s55, 65536
Lfa_nspin:
  v_readfirstlane_b32 s28, v10
  s_nop 3
  s_cmp_lg_u32 s28, 0
  s_cbranch_scc1 Lfa_ngot
  s_sleep 1
  buffer_load_dword v10, v11, s[24:27], 0 offen sc1
  s_waitcnt vmcnt(0)
  s_sub_u32 s55, s55, 1
  s_cmp_lg_u32 s55, 0
  s_cbranch_scc1 Lfa_nspin
Lfa_ngot:
  s_barrier
  s_add_u32 s58, s29, 5
  s_and_b32 s58, s58, 7
  s_lshl_b32 s59, s58, 7
  s_add_u32 s59, s59, s50
  s_mul_i32 s58, s58, 196608
  s_add_u32 s58, s58, s52
  s_add_u32 m0, s51, 32768
  s_add_u32 s54, s59, 0
  buffer_load_dwordx4 v4, s[16:19], s54 offen lds
  s_add_u32 m0, s51, 33792
  s_add_u32 s54, s59, 8192
  buffer_load_dwordx4 v5, s[16:19], s54 offen lds
  s_add_u32 m0, s53, 32768
  s_add_u32 s54, s58, 0
  buffer_load_dwordx4 v6, s[20:23], s54 offen lds
  s_add_u32 m0, s53, 33792
  s_add_u32 s54, s58, 0
  buffer_load_dwordx4 v7, s[20:23], s54 offen lds
  s_add_u32 m0, s53, 34816
  s_add_u32 s54, s58, 0
  buffer_load_dwordx4 v8, s[20:23], s54 offen lds
  s_add_u32 m0, s53, 35840
  s_add_u32 s54, s58, 24576
  buffer_load_dwordx4 v6, s[20:23], s54 offen lds
  s_add_u32 m0, s53, 36864
  s_add_u32 s54, s58, 24576
  buffer_load_dwordx4 v7, s[20:23], s54 offen lds
  s_add_u32 m0, s53, 37888
  s_add_u32 s54, s58, 24576
  buffer_load_dwordx4 v8, s[20:23], s54 offen lds
  s_waitcnt vmcnt(8)
  s_barrier
  s_add_u32 s58, s29, 6
  s_and_b32 s58, s58, 7
  s_lshl_b32 s59, s58, 7
  s_add_u32 s59, s59, s50
  s_mul_i32 s58, s58, 196608
  s_add_u32 s58, s58, s52
  s_add_u32 m0, s51, 65536
  s_add_u32 s54, s59, 0
  buffer_load_dwordx4 v4, s[16:19], s54 offen lds
  s_add_u32 m0, s51, 66560
  s_add_u32 s54, s59, 8192
  buffer_load_dwordx4 v5, s[16:19], s54 offen lds
  s_add_u32 m0, s53, 65536
  s_add_u32 s54, s58, 0
  buffer_load_dwordx4 v6, s[20:23], s54 offen lds
  s_add_u32 m0, s53, 66560
  s_add_u32 s54, s58, 0
  buffer_load_dwordx4 v7, s[20:23], s54 offen lds
  s_add_u32 m0, s53, 67584
  s_add_u32 s54, s58, 0
  buffer_load_dwordx4 v8, s[20:23], s54 offen lds
  s_add_u32 m0, s53, 68608
  s_add_u32 s54, s58, 24576
  buffer_load_dwordx4 v6, s[20:23], s54 offen lds
  s_add_u32 m0, s53, 69632
  s_add_u32 s54, s58, 24576
  buffer_load_dwordx4 v7, s[20:23], s54 offen lds
  s_add_u32 m0, s53, 70656
  s_add_u32 s54, s58, 24576
  buffer_load_dwordx4 v8, s[20:23], s54 offen lds
  s_waitcnt vmcnt(8)
  s_barrier
  s_add_u32 s58, s29, 7
  s_and_b32 s58, s58, 7
  s_lshl_b32 s59, s58, 7
  s_add_u32 s59, s59, s50
  s_mul_i32 s58, s58, 196608
  s_add_u32 s58, s58, s52
  s_add_u32 m0, s51, 98304
  s_add_u32 s54, s59, 0
  buffer_load_dwordx4 v4, s[16:19], s54 offen lds
  s_add_u32 m0, s51, 99328
  s_add_u32 s54, s59, 8192
  buffer_load_dwordx4 v5, s[16:19], s54 offen lds
  s_add_u32 m0, s53, 98304
  s_add_u32 s54, s58, 0
  buffer_load_dwordx4 v6, s[20:23], s54 offen lds
  s_add_u32 m0, s53, 99328
  s_add_u32 s54, s58, 0
  buffer_load_dwordx4 v7, s[20:23], s54 offen lds
  s_add_u32 m0, s53, 100352
  s_add_u32 s54, s58, 0
  buffer_load_dwordx4 v8, s[20:23], s54 offen lds
  s_add_u32 m0, s53, 101376
  s_add_u32 s54, s58, 24576
  buffer_load_dwordx4 v6, s[20:23], s54 offen lds
  s_add_u32 m0, s53, 102400
  s_add_u32 s54, s58, 24576
  buffer_load_dwordx4 v7, s[20:23], s54 offen lds
  s_add_u32 m0, s53, 103424
  s_add_u32 s54, s58, 24576
  buffer_load_dwordx4 v8, s[20:23], s54 offen lds
  s_waitcnt vmcnt(8)
  s_barrier
  s_waitcnt vmcnt(0)
  s_barrier
  s_add_u32 s58, s29, 1
  s_and_b32 s58, s58, 7
  s_lshl_b32 s59, s58, 7
  s_add_u32 s59, s59, s50
  s_mul_i32 s58, s58, 196608
  s_add_u32 s58, s58, s52
  s_add_u32 m0, s51, 32768
  s_add_u32 s54, s59, 0
  buffer_load_dwordx4 v4, s[8:11], s54 offen lds
  s_add_u32 m0, s51, 33792
  s_add_u32 s54, s59, 8192
  buffer_load_dwordx4 v5, s[8:11], s54 offen lds
  s_add_u32 m0, s53, 32768
  s_add_u32 s54, s58, 0
  buffer_load_dwordx4 v6, s[12:15], s54 offen lds
  s_add_u32 m0, s53, 33792
  s_add_u32 s54, s58, 0
  buffer_load_dwordx4 v7, s[12:15], s54 offen lds
  s_add_u32 m0, s53, 34816
  s_add_u32 s54, s58, 0
  buffer_load_dwordx4 v8, s[12:15], s54 offen lds
  s_add_u32 m0, s53, 35840
  s_add_u32 s54, s58, 24576
  buffer_load_dwordx4 v6, s[12:15], s54 offen lds
  s_add_u32 m0, s53, 36864
  s_add_u32 s54, s58, 24576
  buffer_load_dwordx4 v7, s[12:15], s54 offen lds
  s_add_u32 m0, s53, 37888
  s_add_u32 s54, s58, 24576
  buffer_load_dwordx4 v8, s[12:15], s54 offen lds
  s_waitcnt vmcnt(57)
  s_barrier
  s_add_u32 s58, s29, 2
  s_and_b32 s58, s58, 7
  s_lshl_b32 s59, s58, 7
  s_add_u32 s59, s59, s50
  s_mul_i32 s58, s58, 196608
  s_add_u32 s58, s58, s52
  s_add_u32 m0, s51, 65536
  s_add_u32 s54, s59, 0
  buffer_load_dwordx4 v4, s[8:11], s54 offen lds
  s_add_u32 m0, s51, 66560
  s_add_u32 s54, s59, 8192
  buffer_load_dwordx4 v5, s[8:11], s54 offen lds
  s_add_u32 m0, s53, 65536
  s_add_u32 s54, s58, 0
  buffer_load_dwordx4 v6, s[12:15], s54 offen lds
  s_add_u32 m0, s53, 66560
  s_add_u32 s54, s58, 0
  buffer_load_dwordx4 v7, s[12:15], s54 offen lds
  s_add_u32 m0, s53, 67584
  s_add_u32 s54, s58, 0
  buffer_load_dwordx4 v8, s[12:15], s54 offen lds
  s_add_u32 m0, s53, 68608
  s_add_u32 s54, s58, 24576
  buffer_load_dwordx4 v6, s[12:15], s54 offen lds
  s_add_u32 m0, s53, 69632
  s_add_u32 s54, s58, 24576
  buffer_load_dwordx4 v7, s[12:15], s54 offen lds
  s_add_u32 m0, s53, 70656
  s_add_u32 s54, s58, 24576
  buffer_load_dwordx4 v8, s[12:15], s54 offen lds
  s_waitcnt vmcnt(8)
  s_barrier
  s_add_u32 s58, s29, 3
  s_and_b32 s58, s58, 7
  s_lshl_b32 s59, s58, 7
  s_add_u32 s59, s59, s50
  s_mul_i32 s58, s58, 196608
  s_add_u32 s58, s58, s52
  s_add_u32 m0, s51, 98304
  s_add_u32 s54, s59, 0
  buffer_load_dwordx4 v4, s[8:11], s54 offen lds
  s_add_u32 m0, s51, 99328
  s_add_u32 s54, s59, 8192
  buffer_load_dwordx4 v5, s[8:11], s54 offen lds
  s_add_u32 m0, s53, 98304
  s_add_u32 s54, s58, 0
  buffer_load_dwordx4 v6, s[12:15], s54 offen lds
  s_add_u32 m0, s53, 99328
  s_add_u32 s54, s58, 0
  buffer_load_dwordx4 v7, s[12:15], s54 offen lds
  s_add_u32 m0, s53, 100352
  s_add_u32 s54, s58, 0
  buffer_load_dwordx4 v8, s[12:15], s54 offen lds
  s_add_u32 m0, s53, 101376
  s_add_u32 s54, s58, 24576
  buffer_load_dwordx4 v6, s[12:15], s54 offen lds
  s_add_u32 m0, s53, 102400
  s_add_u32 s54, s58, 24576
  buffer_load_dwordx4 v7, s[12:15], s54 offen lds
  s_add_u32 m0, s53, 103424
  s_add_u32 s54, s58, 24576
  buffer_load_dwordx4 v8, s[12:15], s54 offen lds
  s_waitcnt vmcnt(8)
  s_barrier
  s_add_u32 s58, s29, 4
  s_and_b32 s58, s58, 7
  s_lshl_b32 s59, s58, 7
  s_add_u32 s59, s59, s50
  s_mul_i32 s58, s58, 196608
  s_add_u32 s58, s58, s52
  s_add_u32 m0, s51, 0
  s_add_u32 s54, s59, 0
  buffer_load_dwordx4 v4, s[8:11], s54 offen lds
  s_add_u32 m0, s51, 1024
  s_add_u32 s54, s59, 8192
  buffer_load_dwordx4 v5, s[8:11], s54 offen lds
  s_add_u32 m0, s53, 0
  s_add_u32 s54, s58, 0
  buffer_load_dwordx4 v6, s[12:15], s54 offen lds
  s_add_u32 m0, s53, 1024
  s_add_u32 s54, s58, 0
  buffer_load_dwordx4 v7, s[12:15], s54 offen lds
  s_add_u32 m0, s53, 2048
  s_add_u32 s54, s58, 0
  buffer_load_dwordx4 v8, s[12:15], s54 offen lds
  s_add_u32 m0, s53, 3072
  s_add_u32 s54, s58, 24576
  buffer_load_dwordx4 v6, s[12:15], s54 offen lds
  s_add_u32 m0, s53, 4096
  s_add_u32 s54, s58, 24576
  buffer_load_dwordx4 v7, s[12:15], s54 offen lds
  s_add_u32 m0, s53, 5120
  s_add_u32 s54, s58, 24576
  buffer_load_dwordx4 v8, s[12:15], s54 offen lds
  s_cmp_eq_u32 s48, 0
  s_cbranch_scc0 Lfa_nf
  s_add_u32 s56, s74, 16777216
  v_mov_b32 v14, s56
  v_mov_b32 v15, s28
  s_mov_b64 exec, 1
  buffer_store_dword v15, v14, s[4:7], 0 offen sc1
  s_mov_b64 exec, -1
Lfa_nf:
  s_waitcnt vmcnt(8)
  s_barrier
  s_add_u32 s58, s29, 5
  s_and_b32 s58, s58, 7
  s_lshl_b32 s59, s58, 7
  s_add_u32 s59, s59, s50
  s_mul_i32 s58, s58, 196608
  s_add_u32 s58, s58, s52
  s_add_u32 m0, s51, 32768
  s_add_u32 s54, s59, 0
  buffer_load_dwordx4 v4, s[8:11], s54 offen lds
  s_add_u32 m0, s51, 33792
  s_add_u32 s54, s59, 8192
  buffer_load_dwordx4 v5, s[8:11], s54 offen lds
  s_add_u32 m0, s53, 32768
  s_add_u32 s54, s58, 0
  buffer_load_dwordx4 v6, s[12:15], s54 offen lds
  s_add_u32 m0, s53, 33792
  s_add_u32 s54, s58, 0
  buffer_load_dwordx4 v7, s[12:15], s54 offen lds
  s_add_u32 m0, s53, 34816
  s_add_u32 s54, s58, 0
  buffer_load_dwordx4 v8, s[12:15], s54 offen lds
  s_add_u32 m0, s53, 35840
  s_add_u32 s54, s58, 24576
  buffer_load_dwordx4 v6, s[12:15], s54 offen lds
  s_add_u32 m0, s53, 36864
  s_add_u32 s54, s58, 24576
  buffer_load_dwordx4 v7, s[12:15], s54 offen lds
  s_add_u32 m0, s53, 37888
  s_add_u32 s54, s58, 24576
  buffer_load_dwordx4 v8, s[12:15], s54 offen lds
  s_waitcnt vmcnt(8)
  s_barrier
  s_add_u32 s58, s29, 6
  s_and_b32 s58, s58, 7
  s_lshl_b32 s59, s58, 7
  s_add_u32 s59, s59, s50
  s_mul_i32 s58, s58, 196608
  s_add_u32 s58, s58, s52
  s_add_u32 m0, s51, 65536
  s_add_u32 s54, s59, 0
  buffer_load_dwordx4 v4, s[8:11], s54 offen lds
  s_add_u32 m0, s51, 66560
  s_add_u32 s54, s59, 8192
  buffer_load_dwordx4 v5, s[8:11], s54 offen lds
  s_add_u32 m0, s53, 65536
  s_add_u32 s54, s58, 0
  buffer_load_dwordx4 v6, s[12:15], s54 offen lds
  s_add_u32 m0, s53, 66560
  s_add_u32 s54, s58, 0
  buffer_load_dwordx4 v7, s[12:15], s54 offen lds
  s_add_u32 m0, s53, 67584
  s_add_u32 s54, s58, 0
  buffer_load_dwordx4 v8, s[12:15], s54 offen lds
  s_add_u32 m0, s53, 68608
  s_add_u32 s54, s58, 24576
  buffer_load_dwordx4 v6, s[12:15], s54 offen lds
  s_add_u32 m0, s53, 69632
  s_add_u32 s54, s58, 24576
  buffer_load_dwordx4 v7, s[12:15], s54 offen lds
  s_add_u32 m0, s53, 70656
  s_add_u32 s54, s58, 24576
  buffer_load_dwordx4 v8, s[12:15], s54 offen lds
  s_waitcnt vmcnt(8)
  s_barrier
  s_add_u32 s58, s29, 7
  s_and_b32 s58, s58, 7
  s_lshl_b32 s59, s58, 7
  s_add_u32 s59, s59, s50
  s_mul_i32 s58, s58, 196608
  s_add_u32 s58, s58, s52
  s_add_u32 m0, s51, 98304
  s_add_u32 s54, s59, 0
  buffer_load_dwordx4 v4, s[8:11], s54 offen lds
  s_add_u32 m0, s51, 99328
  s_add_u32 s54, s59, 8192
  buffer_load_dwordx4 v5, s[8:11], s54 offen lds
  s_add_u32 m0, s53, 98304
  s_add_u32 s54, s58, 0
  buffer_load_dwordx4 v6, s[12:15], s54 offen lds
  s_add_u32 m0, s53, 99328
  s_add_u32 s54, s58, 0
  buffer_load_dwordx4 v7, s[12:15], s54 offen lds
  s_add_u32 m0, s53, 100352
  s_add_u32 s54, s58, 0
  buffer_load_dwordx4 v8, s[12:15], s54 offen lds
  s_add_u32 m0, s53, 101376
  s_add_u32 s54, s58, 24576
  buffer_load_dwordx4 v6, s[12:15], s54 offen lds
  s_add_u32 m0, s53, 102400
  s_add_u32 s54, s58, 24576
  buffer_load_dwordx4 v7, s[12:15], s54 offen lds
  s_add_u32 m0, s53, 103424
  s_add_u32 s54, s58, 24576
  buffer_load_dwordx4 v8, s[12:15], s54 offen lds
  s_cmp_eq_u32 s48, 0
  s_cbranch_scc0 Lfa_np13
  buffer_load_dword v13, v12, s[4:7], 0 offen sc1
Lfa_np13:
  s_waitcnt vmcnt(8)
  s_barrier
  s_cmp_eq_u32 s48, 0
  s_cbranch_scc0 Lfa_np14
  v_mov_b32 v14, 49152
  v_mov_b32 v16, 0
  ds_write_b32 v14, v16
  s_waitcnt lgkmcnt(0)
Lfa_np14:
  s_cmp_eq_u32 s48, 0
  s_cbranch_scc0 Lfa_w15
  s_waitcnt vmcnt(1)
  s_branch Lfa_w15d
Lfa_w15:
  s_waitcnt vmcnt(0)
Lfa_w15d:
  s_barrier
  s_mov_b32 s55, 65536
  v_mov_b32 v14, 49152
  s_cmp_eq_u32 s48, 0
  s_cbranch_scc0 Lfa_lspin
Lfa_aspin:
  s_waitcnt vmcnt(0)
  v_cmp_eq_u32 vcc, s28, v13
  s_nop 4
  s_cmp_eq_u64 vcc, -1
  s_cbranch_scc1 Lfa_aok
  s_sleep 2
  buffer_load_dword v13, v12, s[4:7], 0 offen sc1
  s_sub_u32 s55, s55, 1
  s_cmp_lg_u32 s55, 0
  s_cbranch_scc1 Lfa_aspin
  s_waitcnt vmcnt(0)
Lfa_aok:
  v_mov_b32 v16, 1
  ds_write_b32 v14, v16
  s_branch Lfa_agot
Lfa_lspin:
  s_mov_b32 s55, 524288
Lfa_lspin2:
  ds_read_b32 v16, v14
  s_waitcnt lgkmcnt(0)
  v_readfirstlane_b32 s56, v16
  s_nop 3
  s_cmp_lg_u32 s56, 0
  s_cbranch_scc1 Lfa_agot
  s_sleep 1
  s_sub_u32 s55, s55, 1
  s_cmp_lg_u32 s55, 0
  s_cbranch_scc1 Lfa_lspin2
Lfa_agot:
  s_mul_i32 s64, s30, 196608
  s_lshl_b32 s65, s48, 10
  s_add_u32 s64, s64, s65
  s_add_u32 m0, s65, 131072
  s_add_u32 s66, s64, 65536
  buffer_load_dwordx4 v247, s[4:7], s66 offen sc1 lds
  s_add_u32 m0, s65, 135168
  s_add_u32 s66, s64, 69632
  buffer_load_dwordx4 v247, s[4:7], s66 offen sc1 lds
  s_add_u32 m0, s65, 139264
  s_add_u32 s66, s64, 73728
  buffer_load_dwordx4 v247, s[4:7], s66 offen sc1 lds
  s_add_u32 m0, s65, 143360
  s_add_u32 s66, s64, 77824
  buffer_load_dwordx4 v247, s[4:7], s66 offen sc1 lds
  s_add_u32 m0, s65, 147456
  s_add_u32 s66, s64, 131072
  buffer_load_dwordx4 v247, s[4:7], s66 offen sc1 lds
  s_add_u32 m0, s65, 151552
  s_add_u32 s66, s64, 135168
  buffer_load_dwordx4 v247, s[4:7], s66 offen sc1 lds
  s_add_u32 m0, s65, 155648
  s_add_u32 s66, s64, 139264
  buffer_load_dwordx4 v247, s[4:7], s66 offen sc1 lds
  s_add_u32 m0, s65, 159744
  s_add_u32 s66, s64, 143360
  buffer_load_dwordx4 v247, s[4:7], s66 offen sc1 lds
  s_lshl_b32 s67, s31, 13
  s_add_u32 s67, s67, s64
  s_add_u32 m0, s65, 32768
  s_add_u32 s66, s67, 0
  buffer_load_dwordx4 v247, s[4:7], s66 offen sc1 lds
  s_add_u32 m0, s65, 36864
  s_add_u32 s66, s67, 4096
  buffer_load_dwordx4 v247, s[4:7], s66 offen sc1 lds
  s_add_u32 m0, s65, 0
  s_add_u32 s66, s64, 81920
  buffer_load_dwordx4 v247, s[4:7], s66 offen sc1 lds
  s_add_u32 m0, s65, 4096
  s_add_u32 s66, s64, 86016
  buffer_load_dwordx4 v247, s[4:7], s66 offen sc1 lds
  s_add_u32 m0, s65, 8192
  s_add_u32 s66, s64, 90112
  buffer_load_dwordx4 v247, s[4:7], s66 offen sc1 lds
  s_add_u32 m0, s65, 12288
  s_add_u32 s66, s64, 94208
  buffer_load_dwordx4 v247, s[4:7], s66 offen sc1 lds
  s_add_u32 m0, s65, 16384
  s_add_u32 s66, s64, 147456
  buffer_load_dwordx4 v247, s[4:7], s66 offen sc1 lds
  s_add_u32 m0, s65, 20480
  s_add_u32 s66, s64, 151552
  buffer_load_dwordx4 v247, s[4:7], s66 offen sc1 lds
  s_add_u32 m0, s65, 24576
  s_add_u32 s66, s64, 155648
  buffer_load_dwordx4 v247, s[4:7], s66 offen sc1 lds
  s_add_u32 m0, s65, 28672
  s_add_u32 s66, s64, 159744
  buffer_load_dwordx4 v247, s[4:7], s66 offen sc1 lds
  s_branch Lfa_attn
Lfa_compute:
  s_lshr_b32 s48, s3, 1
  s_and_b32 s49, s3, 1
  v_and_b32 v2, 31, v1
  v_lshrrev_b32 v3, 5, v1
  v_bfe_u32 v9, v2, 1, 3
  v_xor_b32 v9, v9, v3
  s_lshl_b32 s50, s48, 12
  v_lshlrev_b32 v18, 7, v2
  v_add_u32 v18, s50, v18
  v_xor_b32 v19, 0, v9
  v_lshlrev_b32 v19, 4, v19
  v_add_u32 v10, v18, v19
  v_add_u32 v14, 0x10000, v10
  v_xor_b32 v19, 2, v9
  v_lshlrev_b32 v19, 4, v19
  v_add_u32 v11, v18, v19
  v_add_u32 v15, 0x10000, v11
  v_xor_b32 v19, 4, v9
  v_lshlrev_b32 v19, 4, v19
  v_add_u32 v12, v18, v19
  v_add_u32 v16, 0x10000, v12
  v_xor_b32 v19, 6, v9
  v_lshlrev_b32 v19, 4, v19
  v_add_u32 v13, v18, v19
  v_add_u32 v17, 0x10000, v13
  v_lshlrev_b32 v24, 3, v3
  v_bfe_u32 v25, v1, 2, 2
  v_add_u32 v24, v24, v25
  s_movk_i32 s50, 384
  v_mul_lo_u32 v24, v24, s50
  v_bfe_u32 v25, v1, 4, 1
  v_lshlrev_b32 v25, 5, v25
  v_add_u32 v24, v24, v25
  v_and_b32 v25, 3, v1
  v_lshlrev_b32 v25, 3, v25
  v_add_u32 v24, v24, v25
  v_add_u32 v24, 8192, v24
  v_bfe_u32 v25, v1, 3, 1
  s_mul_i32 s50, s49, 3
  s_add_u32 s51, s50, 0
  v_xor_b32 v26, s51, v25
  v_lshlrev_b32 v26, 6, v26
  v_add_u32 v18, v24, v26
  v_add_u32 v21, 0x10000, v18
  s_add_u32 s51, s50, 1
  v_xor_b32 v26, s51, v25
  v_lshlrev_b32 v26, 6, v26
  v_add_u32 v19, v24, v26
  v_add_u32 v22, 0x10000, v19
  s_add_u32 s51, s50, 2
  v_xor_b32 v26, s51, v25
  v_lshlrev_b32 v26, 6, v26
  v_add_u32 v20, v24, v26
  v_add_u32 v23, 0x10000, v20
  v_lshlrev_b32 v24, 4, v1
  v_bfe_u32 v25, v1, 4, 1
  s_mov_b32 s50, 196608
  v_mul_lo_u32 v25, v25, s50
  v_lshlrev_b32 v26, 8, v3
  v_add_u32 v25, v25, v26
  v_and_b32 v26, 15, v1
  v_lshlrev_b32 v26, 4, v26
  v_add_u32 v25, v25, v26
  s_mul_i32 s52, s32, 786432
  s_lshl_b32 s53, s33, 1
  s_add_u32 s53, s53, s48
  s_lshl_b32 s54, s53, 11
  s_add_u32 s54, s54, 65536
  s_lshl_b32 s53, s53, 10
  s_mov_b32 s55, 0x3eb8aa3b
  v_mov_b32 v64, 0
  v_mov_b32 v65, 0
  v_mov_b32 v66, 0
  v_mov_b32 v67, 0
  v_mov_b32 v68, 0
  v_mov_b32 v69, 0
  v_mov_b32 v70, 0
  v_mov_b32 v71, 0
  v_mov_b32 v72, 0
  v_mov_b32 v73, 0
  v_mov_b32 v74, 0
  v_mov_b32 v75, 0
  v_mov_b32 v76, 0
  v_mov_b32 v77, 0
  v_mov_b32 v78, 0
  v_mov_b32 v79, 0
  v_mov_b32 v80, 0
  v_mov_b32 v81, 0
  v_mov_b32 v82, 0
  v_mov_b32 v83, 0
  v_mov_b32 v84, 0
  v_mov_b32 v85, 0
  v_mov_b32 v86, 0
  v_mov_b32 v87, 0
  v_mov_b32 v88, 0
  v_mov_b32 v89, 0
  v_mov_b32 v90, 0
  v_mov_b32 v91, 0
  v_mov_b32 v92, 0
  v_mov_b32 v93, 0
  v_mov_b32 v94, 0
  v_mov_b32 v95, 0
  v_mov_b32 v96, 0
  v_mov_b32 v97, 0
  v_mov_b32 v98, 0
  v_mov_b32 v99, 0
  v_mov_b32 v100, 0
  v_mov_b32 v101, 0
  v_mov_b32 v102, 0
  v_mov_b32 v103, 0
  v_mov_b32 v104, 0
  v_mov_b32 v105, 0
  v_mov_b32 v106, 0
  v_mov_b32 v107, 0
  v_mov_b32 v108, 0
  v_mov_b32 v109, 0
  v_mov_b32 v110, 0
  v_mov_b32 v111, 0
  v_lshlrev_b32 v247, 4, v1
  v_lshrrev_b32 v250, 5, v1
  v_lshlrev_b32 v3, 8, v250
  v_and_b32 v251, 15, v1
  v_lshlrev_b32 v251, 4, v251
  v_add_u32 v3, v3, v251
  v_add_u32 v3, 1024, v3
  v_and_b32 v251, 27, v1
  v_cmp_eq_u32 vcc, 16, v251
  v_mov_b32 v252, 0x3f803f80
  v_mov_b32 v253, 0
  s_nop 0
  v_cndmask_b32 v160, v253, v252, vcc
  v_cndmask_b32 v161, v253, v252, vcc
  v_cndmask_b32 v162, v253, v252, vcc
  v_cndmask_b32 v163, v253, v252, vcc
  v_cndmask_b32 v164, v253, v252, vcc
  v_cndmask_b32 v165, v253, v252, vcc
  v_cndmask_b32 v166, v253, v252, vcc
  v_cndmask_b32 v167, v253, v252, vcc
  v_cndmask_b32 v168, v253, v252, vcc
  v_cndmask_b32 v169, v253, v252, vcc
  v_cndmask_b32 v170, v253, v252, vcc
  v_cndmask_b32 v171, v253, v252, vcc
  v_cndmask_b32 v172, v253, v252, vcc
  v_cndmask_b32 v173, v253, v252, vcc
  v_cndmask_b32 v174, v253, v252, vcc
  v_cndmask_b32 v175, v253, v252, vcc
  v_and_b32 v251, 31, v1
  v_lshlrev_b32 v250, 2, v250
  v_sub_u32 v251, v251, v250
  v_mov_b32 v252, 0xff800000
  v_cmp_le_i32 s[62:63], 0, v251
  v_cmp_le_i32 s[64:65], 1, v251
  v_cmp_le_i32 s[66:67], 2, v251
  v_cmp_le_i32 s[68:69], 3, v251
  s_nop 1
  v_cndmask_b32 v212, v252, v253, s[62:63]
  v_cndmask_b32 v228, v253, v252, s[62:63]
  v_cndmask_b32 v213, v252, v253, s[64:65]
  v_cndmask_b32 v229, v253, v252, s[64:65]
  v_cndmask_b32 v214, v252, v253, s[66:67]
  v_cndmask_b32 v230, v253, v252, s[66:67]
  v_cndmask_b32 v215, v252, v253, s[68:69]
  v_cndmask_b32 v231, v253, v252, s[68:69]
  v_cmp_le_i32 s[62:63], 8, v251
  v_cmp_le_i32 s[64:65], 9, v251
  v_cmp_le_i32 s[66:67], 10, v251
  v_cmp_le_i32 s[68:69], 11, v251
  s_nop 1
  v_cndmask_b32 v216, v252, v253, s[62:63]
  v_cndmask_b32 v232, v253, v252, s[62:63]
  v_cndmask_b32 v217, v252, v253, s[64:65]
  v_cndmask_b32 v233, v253, v252, s[64:65]
  v_cndmask_b32 v218, v252, v253, s[66:67]
  v_cndmask_b32 v234, v253, v252, s[66:67]
  v_cndmask_b32 v219, v252, v253, s[68:69]
  v_cndmask_b32 v235, v253, v252, s[68:69]
  v_cmp_le_i32 s[62:63], 16, v251
  v_cmp_le_i32 s[64:65], 17, v251
  v_cmp_le_i32 s[66:67], 18, v251
  v_cmp_le_i32 s[68:69], 19, v251
  s_nop 1
  v_cndmask_b32 v220, v252, v253, s[62:63]
  v_cndmask_b32 v236, v253, v252, s[62:63]
  v_cndmask_b32 v221, v252, v253, s[64:65]
  v_cndmask_b32 v237, v253, v252, s[64:65]
  v_cndmask_b32 v222, v252, v253, s[66:67]
  v_cndmask_b32 v238, v253, v252, s[66:67]
  v_cndmask_b32 v223, v252, v253, s[68:69]
  v_cndmask_b32 v239, v253, v252, s[68:69]
  v_cmp_le_i32 s[62:63], 24, v251
  v_cmp_le_i32 s[64:65], 25, v251
  v_cmp_le_i32 s[66:67], 26, v251
  v_cmp_le_i32 s[68:69], 27, v251
  s_nop 1
  v_cndmask_b32 v224, v252, v253, s[62:63]
  v_cndmask_b32 v240, v253, v252, s[62:63]
  v_cndmask_b32 v225, v252, v253, s[64:65]
  v_cndmask_b32 v241, v253, v252, s[64:65]
  v_cndmask_b32 v226, v252, v253, s[66:67]
  v_cndmask_b32 v242, v253, v252, s[66:67]
  v_cndmask_b32 v227, v252, v253, s[68:69]
  v_cndmask_b32 v243, v253, v252, s[68:69]
  s_lshr_b32 s70, s3, 2
  s_lshl_b32 s71, s70, 14
  s_add_u32 s72, s71, 131072
  v_add_u32 v254, s71, v247
  v_add_u32 v255, s71, v3
  v_add_u32 v244, s72, v247
  v_add_u32 v245, s72, v3
  s_mov_b32 s73, 0
  s_mov_b32 s40, 0x0000ffff
  s_mov_b32 s41, 0x0000ffff
  s_waitcnt lgkmcnt(0)
  s_mov_b32 s4, s46
  s_and_b32 s5, s47, 0xffff
  s_mov_b32 s6, 17825792
  s_mov_b32 s7, 0x00020000
  s_cmp_eq_u32 s49, 0
  s_cbranch_scc0 Lfa_wn1
  s_mov_b32 s57, 0
Lpj0_loop:
  s_barrier
  ds_read_b128 v[28:31], v10 offset:0
  ds_read_b64_tr_b16 v[36:37], v18 offset:0
  ds_read_b64_tr_b16 v[38:39], v18 offset:1536
  ds_read_b64_tr_b16 v[40:41], v19 offset:0
  ds_read_b64_tr_b16 v[42:43], v19 offset:1536
  ds_read_b64_tr_b16 v[44:45], v20 offset:0
  ds_read_b64_tr_b16 v[46:47], v20 offset:1536
  ds_read_b128 v[32:35], v11 offset:0
  ds_read_b64_tr_b16 v[48:49], v18 offset:6144
  ds_read_b64_tr_b16 v[50:51], v18 offset:7680
  ds_read_b64_tr_b16 v[52:53], v19 offset:6144
  ds_read_b64_tr_b16 v[54:55], v19 offset:7680
  ds_read_b64_tr_b16 v[56:57], v20 offset:6144
  ds_read_b64_tr_b16 v[58:59], v20 offset:7680
  s_waitcnt lgkmcnt(7)
  v_mfma_f32_32x32x16_bf16 v[64:79], v[36:39], v[28:31], v[64:79]
  v_mfma_f32_32x32x16_bf16 v[80:95], v[40:43], v[28:31], v[80:95]
  v_mfma_f32_32x32x16_bf16 v[96:111], v[44:47], v[28:31], v[96:111]
  ds_read_b128 v[28:31], v12 offset:0
  ds_read_b64_tr_b16 v[36:37], v18 offset:12288
  ds_read_b64_tr_b16 v[38:39], v18 offset:13824
  ds_read_b64_tr_b16 v[40:41], v19 offset:12288
  ds_read_b64_tr_b16 v[42:43], v19 offset:13824
  ds_read_b64_tr_b16 v[44:45], v20 offset:12288
  ds_read_b64_tr_b16 v[46:47], v20 offset:13824
  s_waitcnt lgkmcnt(7)
  v_mfma_f32_32x32x16_bf16 v[64:79], v[48:51], v[32:35], v[64:79]
  v_mfma_f32_32x32x16_bf16 v[80:95], v[52:55], v[32:35], v[80:95]
  v_mfma_f32_32x32x16_bf16 v[96:111], v[56:59], v[32:35], v[96:111]
  ds_read_b128 v[32:35], v13 offset:0
  ds_read_b64_tr_b16 v[48:49], v18 offset:18432
  ds_read_b64_tr_b16 v[50:51], v18 offset:19968
  ds_read_b64_tr_b16 v[52:53], v19 offset:18432
  ds_read_b64_tr_b16 v[54:55], v19 offset:19968
  ds_read_b64_tr_b16 v[56:57], v20 offset:18432
  ds_read_b64_tr_b16 v[58:59], v20 offset:19968
  s_waitcnt lgkmcnt(7)
  v_mfma_f32_32x32x16_bf16 v[64:79], v[36:39], v[28:31], v[64:79]
  v_mfma_f32_32x32x16_bf16 v[80:95], v[40:43], v[28:31], v[80:95]
  v_mfma_f32_32x32x16_bf16 v[96:111], v[44:47], v[28:31], v[96:111]
  s_waitcnt lgkmcnt(0)
  v_mfma_f32_32x32x16_bf16 v[64:79], v[48:51], v[32:35], v[64:79]
  v_mfma_f32_32x32x16_bf16 v[80:95], v[52:55], v[32:35], v[80:95]
  v_mfma_f32_32x32x16_bf16 v[96:111], v[56:59], v[32:35], v[96:111]
  s_barrier
  ds_read_b128 v[28:31], v10 offset:32768
  ds_read_b64_tr_b16 v[36:37], v18 offset:32768
  ds_read_b64_tr_b16 v[38:39], v18 offset:34304
  ds_read_b64_tr_b16 v[40:41], v19 offset:32768
  ds_read_b64_tr_b16 v[42:43], v19 offset:34304
  ds_read_b64_tr_b16 v[44:45], v20 offset:32768
  ds_read_b64_tr_b16 v[46:47], v20 offset:34304
  ds_read_b128 v[32:35], v11 offset:32768
  ds_read_b64_tr_b16 v[48:49], v18 offset:38912
  ds_read_b64_tr_b16 v[50:51], v18 offset:40448
  ds_read_b64_tr_b16 v[52:53], v19 offset:38912
  ds_read_b64_tr_b16 v[54:55], v19 offset:40448
  ds_read_b64_tr_b16 v[56:57], v20 offset:38912
  ds_read_b64_tr_b16 v[58:59], v20 offset:40448
  s_waitcnt lgkmcnt(7)
  v_mfma_f32_32x32x16_bf16 v[64:79], v[36:39], v[28:31], v[64:79]
  v_mfma_f32_32x32x16_bf16 v[80:95], v[40:43], v[28:31], v[80:95]
  v_mfma_f32_32x32x16_bf16 v[96:111], v[44:47], v[28:31], v[96:111]
  ds_read_b128 v[28:31], v12 offset:32768
  ds_read_b64_tr_b16 v[36:37], v18 offset:45056
  ds_read_b64_tr_b16 v[38:39], v18 offset:46592
  ds_read_b64_tr_b16 v[40:41], v19 offset:45056
  ds_read_b64_tr_b16 v[42:43], v19 offset:46592
  ds_read_b64_tr_b16 v[44:45], v20 offset:45056
  ds_read_b64_tr_b16 v[46:47], v20 offset:46592
  s_waitcnt lgkmcnt(7)
  v_mfma_f32_32x32x16_bf16 v[64:79], v[48:51], v[32:35], v[64:79]
  v_mfma_f32_32x32x16_bf16 v[80:95], v[52:55], v[32:35], v[80:95]
  v_mfma_f32_32x32x16_bf16 v[96:111], v[56:59], v[32:35], v[96:111]
  ds_read_b128 v[32:35], v13 offset:32768
  ds_read_b64_tr_b16 v[48:49], v18 offset:51200
  ds_read_b64_tr_b16 v[50:51], v18 offset:52736
  ds_read_b64_tr_b16 v[52:53], v19 offset:51200
  ds_read_b64_tr_b16 v[54:55], v19 offset:52736
  ds_read_b64_tr_b16 v[56:57], v20 offset:51200
  ds_read_b64_tr_b16 v[58:59], v20 offset:52736
  s_waitcnt lgkmcnt(7)
  v_mfma_f32_32x32x16_bf16 v[64:79], v[36:39], v[28:31], v[64:79]
  v_mfma_f32_32x32x16_bf16 v[80:95], v[40:43], v[28:31], v[80:95]
  v_mfma_f32_32x32x16_bf16 v[96:111], v[44:47], v[28:31], v[96:111]
  s_waitcnt lgkmcnt(0)
  v_mfma_f32_32x32x16_bf16 v[64:79], v[48:51], v[32:35], v[64:79]
  v_mfma_f32_32x32x16_bf16 v[80:95], v[52:55], v[32:35], v[80:95]
  v_mfma_f32_32x32x16_bf16 v[96:111], v[56:59], v[32:35], v[96:111]
  s_barrier
  ds_read_b128 v[28:31], v14 offset:0
  ds_read_b64_tr_b16 v[36:37], v21 offset:0
  ds_read_b64_tr_b16 v[38:39], v21 offset:1536
  ds_read_b64_tr_b16 v[40:41], v22 offset:0
  ds_read_b64_tr_b16 v[42:43], v22 offset:1536
  ds_read_b64_tr_b16 v[44:45], v23 offset:0
  ds_read_b64_tr_b16 v[46:47], v23 offset:1536
  ds_read_b128 v[32:35], v15 offset:0
  ds_read_b64_tr_b16 v[48:49], v21 offset:6144
  ds_read_b64_tr_b16 v[50:51], v21 offset:7680
  ds_read_b64_tr_b16 v[52:53], v22 offset:6144
  ds_read_b64_tr_b16 v[54:55], v22 offset:7680
  ds_read_b64_tr_b16 v[56:57], v23 offset:6144
  ds_read_b64_tr_b16 v[58:59], v23 offset:7680
  s_waitcnt lgkmcnt(7)
  v_mfma_f32_32x32x16_bf16 v[64:79], v[36:39], v[28:31], v[64:79]
  v_mfma_f32_32x32x16_bf16 v[80:95], v[40:43], v[28:31], v[80:95]
  v_mfma_f32_32x32x16_bf16 v[96:111], v[44:47], v[28:31], v[96:111]
  ds_read_b128 v[28:31], v16 offset:0
  ds_read_b64_tr_b16 v[36:37], v21 offset:12288
  ds_read_b64_tr_b16 v[38:39], v21 offset:13824
  ds_read_b64_tr_b16 v[40:41], v22 offset:12288
  ds_read_b64_tr_b16 v[42:43], v22 offset:13824
  ds_read_b64_tr_b16 v[44:45], v23 offset:12288
  ds_read_b64_tr_b16 v[46:47], v23 offset:13824
  s_waitcnt lgkmcnt(7)
  v_mfma_f32_32x32x16_bf16 v[64:79], v[48:51], v[32:35], v[64:79]
  v_mfma_f32_32x32x16_bf16 v[80:95], v[52:55], v[32:35], v[80:95]
  v_mfma_f32_32x32x16_bf16 v[96:111], v[56:59], v[32:35], v[96:111]
  ds_read_b128 v[32:35], v17 offset:0
  ds_read_b64_tr_b16 v[48:49], v21 offset:18432
  ds_read_b64_tr_b16 v[50:51], v21 offset:19968
  ds_read_b64_tr_b16 v[52:53], v22 offset:18432
  ds_read_b64_tr_b16 v[54:55], v22 offset:19968
  ds_read_b64_tr_b16 v[56:57], v23 offset:18432
  ds_read_b64_tr_b16 v[58:59], v23 offset:19968
  s_waitcnt lgkmcnt(7)
  v_mfma_f32_32x32x16_bf16 v[64:79], v[36:39], v[28:31], v[64:79]
  v_mfma_f32_32x32x16_bf16 v[80:95], v[40:43], v[28:31], v[80:95]
  v_mfma_f32_32x32x16_bf16 v[96:111], v[44:47], v[28:31], v[96:111]
  s_waitcnt lgkmcnt(0)
  v_mfma_f32_32x32x16_bf16 v[64:79], v[48:51], v[32:35], v[64:79]
  v_mfma_f32_32x32x16_bf16 v[80:95], v[52:55], v[32:35], v[80:95]
  v_mfma_f32_32x32x16_bf16 v[96:111], v[56:59], v[32:35], v[96:111]
  s_barrier
  ds_read_b128 v[28:31], v14 offset:32768
  ds_read_b64_tr_b16 v[36:37], v21 offset:32768
  ds_read_b64_tr_b16 v[38:39], v21 offset:34304
  ds_read_b64_tr_b16 v[40:41], v22 offset:32768
  ds_read_b64_tr_b16 v[42:43], v22 offset:34304
  ds_read_b64_tr_b16 v[44:45], v23 offset:32768
  ds_read_b64_tr_b16 v[46:47], v23 offset:34304
  ds_read_b128 v[32:35], v15 offset:32768
  ds_read_b64_tr_b16 v[48:49], v21 offset:38912
  ds_read_b64_tr_b16 v[50:51], v21 offset:40448
  ds_read_b64_tr_b16 v[52:53], v22 offset:38912
  ds_read_b64_tr_b16 v[54:55], v22 offset:40448
  ds_read_b64_tr_b16 v[56:57], v23 offset:38912
  ds_read_b64_tr_b16 v[58:59], v23 offset:40448
  s_waitcnt lgkmcnt(7)
  v_mfma_f32_32x32x16_bf16 v[64:79], v[36:39], v[28:31], v[64:79]
  v_mfma_f32_32x32x16_bf16 v[80:95], v[40:43], v[28:31], v[80:95]
  v_mfma_f32_32x32x16_bf16 v[96:111], v[44:47], v[28:31], v[96:111]
  ds_read_b128 v[28:31], v16 offset:32768
  ds_read_b64_tr_b16 v[36:37], v21 offset:45056
  ds_read_b64_tr_b16 v[38:39], v21 offset:46592
  ds_read_b64_tr_b16 v[40:41], v22 offset:45056
  ds_read_b64_tr_b16 v[42:43], v22 offset:46592
  ds_read_b64_tr_b16 v[44:45], v23 offset:45056
  ds_read_b64_tr_b16 v[46:47], v23 offset:46592
  s_waitcnt lgkmcnt(7)
  v_mfma_f32_32x32x16_bf16 v[64:79], v[48:51], v[32:35], v[64:79]
  v_mfma_f32_32x32x16_bf16 v[80:95], v[52:55], v[32:35], v[80:95]
  v_mfma_f32_32x32x16_bf16 v[96:111], v[56:59], v[32:35], v[96:111]
  ds_read_b128 v[32:35], v17 offset:32768
  ds_read_b64_tr_b16 v[48:49], v21 offset:51200
  ds_read_b64_tr_b16 v[50:51], v21 offset:52736
  ds_read_b64_tr_b16 v[52:53], v22 offset:51200
  ds_read_b64_tr_b16 v[54:55], v22 offset:52736
  ds_read_b64_tr_b16 v[56:57], v23 offset:51200
  ds_read_b64_tr_b16 v[58:59], v23 offset:52736
  s_waitcnt lgkmcnt(7)
  v_mfma_f32_32x32x16_bf16 v[64:79], v[36:39], v[28:31], v[64:79]
  v_mfma_f32_32x32x16_bf16 v[80:95], v[40:43], v[28:31], v[80:95]
  v_mfma_f32_32x32x16_bf16 v[96:111], v[44:47], v[28:31], v[96:111]
  s_waitcnt lgkmcnt(0)
  v_mfma_f32_32x32x16_bf16 v[64:79], v[48:51], v[32:35], v[64:79]
  v_mfma_f32_32x32x16_bf16 v[80:95], v[52:55], v[32:35], v[80:95]
  v_mfma_f32_32x32x16_bf16 v[96:111], v[56:59], v[32:35], v[96:111]
  s_add_u32 s57, s57, 1
  s_cmp_lt_u32 s57, 2
  s_cbranch_scc1 Lpj0_loop
  s_barrier
  v_add_u32 v10, 131072, v10
  v_add_u32 v11, 131072, v11
  v_add_u32 v12, 131072, v12
  v_add_u32 v13, 131072, v13
  v_add_u32 v18, 131072, v18
  v_add_u32 v19, 131072, v19
  v_add_u32 v20, 131072, v20
  s_nop 7
  ds_read_b128 v[28:31], v10 offset:0
  ds_read_b64_tr_b16 v[36:37], v18 offset:0
  ds_read_b64_tr_b16 v[38:39], v18 offset:1536
  ds_read_b64_tr_b16 v[40:41], v19 offset:0
  ds_read_b64_tr_b16 v[42:43], v19 offset:1536
  ds_read_b64_tr_b16 v[44:45], v20 offset:0
  ds_read_b64_tr_b16 v[46:47], v20 offset:1536
  ds_read_b128 v[32:35], v11 offset:0
  ds_read_b64_tr_b16 v[48:49], v18 offset:6144
  ds_read_b64_tr_b16 v[50:51], v18 offset:7680
  ds_read_b64_tr_b16 v[52:53], v19 offset:6144
  ds_read_b64_tr_b16 v[54:55], v19 offset:7680
  ds_read_b64_tr_b16 v[56:57], v20 offset:6144
  ds_read_b64_tr_b16 v[58:59], v20 offset:7680
  s_waitcnt lgkmcnt(7)
  v_mfma_f32_32x32x16_bf16 v[128:143], v[36:39], v[28:31], 0
  v_mfma_f32_32x32x16_bf16 v[144:159], v[40:43], v[28:31], 0
  v_mfma_f32_32x32x16_bf16 v[176:191], v[44:47], v[28:31], 0
  v_mul_f32 v64, s55, v64
  v_mul_f32 v65, s55, v65
  v_mul_f32 v66, s55, v66
  v_mul_f32 v67, s55, v67
  v_mul_f32 v68, s55, v68
  v_mul_f32 v69, s55, v69
  v_mul_f32 v70, s55, v70
  v_mul_f32 v71, s55, v71
  v_cvt_pk_bf16_f32 v112, v64, v65
  v_cvt_pk_bf16_f32 v113, v66, v67
  v_cvt_pk_bf16_f32 v114, v68, v69
  v_cvt_pk_bf16_f32 v115, v70, v71
  s_add_u32 s59, s52, 0
  s_add_u32 s59, s59, s53
  buffer_store_dwordx4 v[112:115], v24, s[4:7], s59 offen sc1
  v_mul_f32 v72, s55, v72
  v_mul_f32 v73, s55, v73
  v_mul_f32 v74, s55, v74
  v_mul_f32 v75, s55, v75
  v_mul_f32 v76, s55, v76
  v_mul_f32 v77, s55, v77
  v_mul_f32 v78, s55, v78
  v_mul_f32 v79, s55, v79
  v_cvt_pk_bf16_f32 v116, v72, v73
  v_cvt_pk_bf16_f32 v117, v74, v75
  v_cvt_pk_bf16_f32 v118, v76, v77
  v_cvt_pk_bf16_f32 v119, v78, v79
  s_add_u32 s59, s52, 196608
  s_add_u32 s59, s59, s53
  buffer_store_dwordx4 v[116:119], v24, s[4:7], s59 offen sc1
  ds_read_b128 v[28:31], v12 offset:0
  ds_read_b64_tr_b16 v[36:37], v18 offset:12288
  ds_read_b64_tr_b16 v[38:39], v18 offset:13824
  ds_read_b64_tr_b16 v[40:41], v19 offset:12288
  ds_read_b64_tr_b16 v[42:43], v19 offset:13824
  ds_read_b64_tr_b16 v[44:45], v20 offset:12288
  ds_read_b64_tr_b16 v[46:47], v20 offset:13824
  s_waitcnt lgkmcnt(7)
  v_mfma_f32_32x32x16_bf16 v[128:143], v[48:51], v[32:35], v[128:143]
  v_mfma_f32_32x32x16_bf16 v[144:159], v[52:55], v[32:35], v[144:159]
  v_mfma_f32_32x32x16_bf16 v[176:191], v[56:59], v[32:35], v[176:191]
  v_mul_f32 v80, s55, v80
  v_mul_f32 v81, s55, v81
  v_mul_f32 v82, s55, v82
  v_mul_f32 v83, s55, v83
  v_mul_f32 v84, s55, v84
  v_mul_f32 v85, s55, v85
  v_mul_f32 v86, s55, v86
  v_mul_f32 v87, s55, v87
  v_cvt_pk_bf16_f32 v120, v80, v81
  v_cvt_pk_bf16_f32 v121, v82, v83
  v_cvt_pk_bf16_f32 v122, v84, v85
  v_cvt_pk_bf16_f32 v123, v86, v87
  s_add_u32 s59, s52, 393216
  s_add_u32 s59, s59, s53
  buffer_store_dwordx4 v[120:123], v24, s[4:7], s59 offen sc1
  v_mul_f32 v88, s55, v88
  v_mul_f32 v89, s55, v89
  v_mul_f32 v90, s55, v90
  v_mul_f32 v91, s55, v91
  v_mul_f32 v92, s55, v92
  v_mul_f32 v93, s55, v93
  v_mul_f32 v94, s55, v94
  v_mul_f32 v95, s55, v95
  v_cvt_pk_bf16_f32 v124, v88, v89
  v_cvt_pk_bf16_f32 v125, v90, v91
  v_cvt_pk_bf16_f32 v126, v92, v93
  v_cvt_pk_bf16_f32 v127, v94, v95
  s_add_u32 s59, s52, 589824
  s_add_u32 s59, s59, s53
  buffer_store_dwordx4 v[124:127], v24, s[4:7], s59 offen sc1
  ds_read_b128 v[32:35], v13 offset:0
  ds_read_b64_tr_b16 v[48:49], v18 offset:18432
  ds_read_b64_tr_b16 v[50:51], v18 offset:19968
  ds_read_b64_tr_b16 v[52:53], v19 offset:18432
  ds_read_b64_tr_b16 v[54:55], v19 offset:19968
  ds_read_b64_tr_b16 v[56:57], v20 offset:18432
  ds_read_b64_tr_b16 v[58:59], v20 offset:19968
  s_waitcnt lgkmcnt(7)
  v_mfma_f32_32x32x16_bf16 v[128:143], v[36:39], v[28:31], v[128:143]
  v_mfma_f32_32x32x16_bf16 v[144:159], v[40:43], v[28:31], v[144:159]
  v_mfma_f32_32x32x16_bf16 v[176:191], v[44:47], v[28:31], v[176:191]
  v_cvt_pk_bf16_f32 v112, v96, v97
  v_cvt_pk_bf16_f32 v113, v98, v99
  v_cvt_pk_bf16_f32 v114, v100, v101
  v_cvt_pk_bf16_f32 v115, v102, v103
  s_add_u32 s59, s52, 0
  s_add_u32 s59, s59, s54
  buffer_store_dwordx4 v[112:115], v24, s[4:7], s59 offen sc1
  v_cvt_pk_bf16_f32 v116, v104, v105
  v_cvt_pk_bf16_f32 v117, v106, v107
  v_cvt_pk_bf16_f32 v118, v108, v109
  v_cvt_pk_bf16_f32 v119, v110, v111
  s_add_u32 s59, s52, 196608
  s_add_u32 s59, s59, s54
  buffer_store_dwordx4 v[116:119], v24, s[4:7], s59 offen sc1
  s_waitcnt lgkmcnt(0)
  v_mfma_f32_32x32x16_bf16 v[128:143], v[48:51], v[32:35], v[128:143]
  v_mfma_f32_32x32x16_bf16 v[144:159], v[52:55], v[32:35], v[144:159]
  v_mfma_f32_32x32x16_bf16 v[176:191], v[56:59], v[32:35], v[176:191]
  v_subrev_u32 v10, 131072, v10
  v_subrev_u32 v11, 131072, v11
  v_subrev_u32 v12, 131072, v12
  v_subrev_u32 v13, 131072, v13
  v_subrev_u32 v18, 131072, v18
  v_subrev_u32 v19, 131072, v19
  v_subrev_u32 v20, 131072, v20
  s_barrier
  s_waitcnt vmcnt(0)
  ds_read_b128 v[28:31], v10 offset:32768
  ds_read_b64_tr_b16 v[36:37], v18 offset:32768
  ds_read_b64_tr_b16 v[38:39], v18 offset:34304
  ds_read_b64_tr_b16 v[40:41], v19 offset:32768
  ds_read_b64_tr_b16 v[42:43], v19 offset:34304
  ds_read_b64_tr_b16 v[44:45], v20 offset:32768
  ds_read_b64_tr_b16 v[46:47], v20 offset:34304
  ds_read_b128 v[32:35], v11 offset:32768
  ds_read_b64_tr_b16 v[48:49], v18 offset:38912
  ds_read_b64_tr_b16 v[50:51], v18 offset:40448
  ds_read_b64_tr_b16 v[52:53], v19 offset:38912
  ds_read_b64_tr_b16 v[54:55], v19 offset:40448
  ds_read_b64_tr_b16 v[56:57], v20 offset:38912
  ds_read_b64_tr_b16 v[58:59], v20 offset:40448
  s_waitcnt lgkmcnt(7)
  v_mfma_f32_32x32x16_bf16 v[128:143], v[36:39], v[28:31], v[128:143]
  v_mfma_f32_32x32x16_bf16 v[144:159], v[40:43], v[28:31], v[144:159]
  v_mfma_f32_32x32x16_bf16 v[176:191], v[44:47], v[28:31], v[176:191]
  ds_read_b128 v[28:31], v12 offset:32768
  ds_read_b64_tr_b16 v[36:37], v18 offset:45056
  ds_read_b64_tr_b16 v[38:39], v18 offset:46592
  ds_read_b64_tr_b16 v[40:41], v19 offset:45056
  ds_read_b64_tr_b16 v[42:43], v19 offset:46592
  ds_read_b64_tr_b16 v[44:45], v20 offset:45056
  ds_read_b64_tr_b16 v[46:47], v20 offset:46592
  s_waitcnt lgkmcnt(7)
  v_mfma_f32_32x32x16_bf16 v[128:143], v[48:51], v[32:35], v[128:143]
  v_mfma_f32_32x32x16_bf16 v[144:159], v[52:55], v[32:35], v[144:159]
  v_mfma_f32_32x32x16_bf16 v[176:191], v[56:59], v[32:35], v[176:191]
  ds_read_b128 v[32:35], v13 offset:32768
  ds_read_b64_tr_b16 v[48:49], v18 offset:51200
  ds_read_b64_tr_b16 v[50:51], v18 offset:52736
  ds_read_b64_tr_b16 v[52:53], v19 offset:51200
  ds_read_b64_tr_b16 v[54:55], v19 offset:52736
  ds_read_b64_tr_b16 v[56:57], v20 offset:51200
  ds_read_b64_tr_b16 v[58:59], v20 offset:52736
  s_waitcnt lgkmcnt(7)
  v_mfma_f32_32x32x16_bf16 v[128:143], v[36:39], v[28:31], v[128:143]
  v_mfma_f32_32x32x16_bf16 v[144:159], v[40:43], v[28:31], v[144:159]
  v_mfma_f32_32x32x16_bf16 v[176:191], v[44:47], v[28:31], v[176:191]
  s_waitcnt lgkmcnt(0)
  v_mfma_f32_32x32x16_bf16 v[128:143], v[48:51], v[32:35], v[128:143]
  v_mfma_f32_32x32x16_bf16 v[144:159], v[52:55], v[32:35], v[144:159]
  v_mfma_f32_32x32x16_bf16 v[176:191], v[56:59], v[32:35], v[176:191]
  s_barrier
  ds_read_b128 v[28:31], v14 offset:0
  ds_read_b64_tr_b16 v[36:37], v21 offset:0
  ds_read_b64_tr_b16 v[38:39], v21 offset:1536
  ds_read_b64_tr_b16 v[40:41], v22 offset:0
  ds_read_b64_tr_b16 v[42:43], v22 offset:1536
  ds_read_b64_tr_b16 v[44:45], v23 offset:0
  ds_read_b64_tr_b16 v[46:47], v23 offset:1536
  ds_read_b128 v[32:35], v15 offset:0
  ds_read_b64_tr_b16 v[48:49], v21 offset:6144
  ds_read_b64_tr_b16 v[50:51], v21 offset:7680
  ds_read_b64_tr_b16 v[52:53], v22 offset:6144
  ds_read_b64_tr_b16 v[54:55], v22 offset:7680
  ds_read_b64_tr_b16 v[56:57], v23 offset:6144
  ds_read_b64_tr_b16 v[58:59], v23 offset:7680
  s_waitcnt lgkmcnt(7)
  v_mfma_f32_32x32x16_bf16 v[128:143], v[36:39], v[28:31], v[128:143]
  v_mfma_f32_32x32x16_bf16 v[144:159], v[40:43], v[28:31], v[144:159]
  v_mfma_f32_32x32x16_bf16 v[176:191], v[44:47], v[28:31], v[176:191]
  ds_read_b128 v[28:31], v16 offset:0
  ds_read_b64_tr_b16 v[36:37], v21 offset:12288
  ds_read_b64_tr_b16 v[38:39], v21 offset:13824
  ds_read_b64_tr_b16 v[40:41], v22 offset:12288
  ds_read_b64_tr_b16 v[42:43], v22 offset:13824
  ds_read_b64_tr_b16 v[44:45], v23 offset:12288
  ds_read_b64_tr_b16 v[46:47], v23 offset:13824
  s_waitcnt lgkmcnt(7)
  v_mfma_f32_32x32x16_bf16 v[128:143], v[48:51], v[32:35], v[128:143]
  v_mfma_f32_32x32x16_bf16 v[144:159], v[52:55], v[32:35], v[144:159]
  v_mfma_f32_32x32x16_bf16 v[176:191], v[56:59], v[32:35], v[176:191]
  ds_read_b128 v[32:35], v17 offset:0
  ds_read_b64_tr_b16 v[48:49], v21 offset:18432
  ds_read_b64_tr_b16 v[50:51], v21 offset:19968
  ds_read_b64_tr_b16 v[52:53], v22 offset:18432
  ds_read_b64_tr_b16 v[54:55], v22 offset:19968
  ds_read_b64_tr_b16 v[56:57], v23 offset:18432
  ds_read_b64_tr_b16 v[58:59], v23 offset:19968
  s_waitcnt lgkmcnt(7)
  v_mfma_f32_32x32x16_bf16 v[128:143], v[36:39], v[28:31], v[128:143]
  v_mfma_f32_32x32x16_bf16 v[144:159], v[40:43], v[28:31], v[144:159]
  v_mfma_f32_32x32x16_bf16 v[176:191], v[44:47], v[28:31], v[176:191]
  s_waitcnt lgkmcnt(0)
  v_mfma_f32_32x32x16_bf16 v[128:143], v[48:51], v[32:35], v[128:143]
  v_mfma_f32_32x32x16_bf16 v[144:159], v[52:55], v[32:35], v[144:159]
  v_mfma_f32_32x32x16_bf16 v[176:191], v[56:59], v[32:35], v[176:191]
  s_barrier
  ds_read_b128 v[28:31], v14 offset:32768
  ds_read_b64_tr_b16 v[36:37], v21 offset:32768
  ds_read_b64_tr_b16 v[38:39], v21 offset:34304
  ds_read_b64_tr_b16 v[40:41], v22 offset:32768
  ds_read_b64_tr_b16 v[42:43], v22 offset:34304
  ds_read_b64_tr_b16 v[44:45], v23 offset:32768
  ds_read_b64_tr_b16 v[46:47], v23 offset:34304
  ds_read_b128 v[32:35], v15 offset:32768
  ds_read_b64_tr_b16 v[48:49], v21 offset:38912
  ds_read_b64_tr_b16 v[50:51], v21 offset:40448
  ds_read_b64_tr_b16 v[52:53], v22 offset:38912
  ds_read_b64_tr_b16 v[54:55], v22 offset:40448
  ds_read_b64_tr_b16 v[56:57], v23 offset:38912
  ds_read_b64_tr_b16 v[58:59], v23 offset:40448
  s_waitcnt lgkmcnt(7)
  v_mfma_f32_32x32x16_bf16 v[128:143], v[36:39], v[28:31], v[128:143]
  v_mfma_f32_32x32x16_bf16 v[144:159], v[40:43], v[28:31], v[144:159]
  v_mfma_f32_32x32x16_bf16 v[176:191], v[44:47], v[28:31], v[176:191]
  ds_read_b128 v[28:31], v16 offset:32768
  ds_read_b64_tr_b16 v[36:37], v21 offset:45056
  ds_read_b64_tr_b16 v[38:39], v21 offset:46592
  ds_read_b64_tr_b16 v[40:41], v22 offset:45056
  ds_read_b64_tr_b16 v[42:43], v22 offset:46592
  ds_read_b64_tr_b16 v[44:45], v23 offset:45056
  ds_read_b64_tr_b16 v[46:47], v23 offset:46592
  s_waitcnt lgkmcnt(7)
  v_mfma_f32_32x32x16_bf16 v[128:143], v[48:51], v[32:35], v[128:143]
  v_mfma_f32_32x32x16_bf16 v[144:159], v[52:55], v[32:35], v[144:159]
  v_mfma_f32_32x32x16_bf16 v[176:191], v[56:59], v[32:35], v[176:191]
  ds_read_b128 v[32:35], v17 offset:32768
  ds_read_b64_tr_b16 v[48:49], v21 offset:51200
  ds_read_b64_tr_b16 v[50:51], v21 offset:52736
  ds_read_b64_tr_b16 v[52:53], v22 offset:51200
  ds_read_b64_tr_b16 v[54:55], v22 offset:52736
  ds_read_b64_tr_b16 v[56:57], v23 offset:51200
  ds_read_b64_tr_b16 v[58:59], v23 offset:52736
  s_waitcnt lgkmcnt(7)
  v_mfma_f32_32x32x16_bf16 v[128:143], v[36:39], v[28:31], v[128:143]
  v_mfma_f32_32x32x16_bf16 v[144:159], v[40:43], v[28:31], v[144:159]
  v_mfma_f32_32x32x16_bf16 v[176:191], v[44:47], v[28:31], v[176:191]
  s_waitcnt lgkmcnt(0)
  v_mfma_f32_32x32x16_bf16 v[128:143], v[48:51], v[32:35], v[128:143]
  v_mfma_f32_32x32x16_bf16 v[144:159], v[52:55], v[32:35], v[144:159]
  v_mfma_f32_32x32x16_bf16 v[176:191], v[56:59], v[32:35], v[176:191]
  s_barrier
  ds_read_b128 v[28:31], v10 offset:0
  ds_read_b64_tr_b16 v[36:37], v18 offset:0
  ds_read_b64_tr_b16 v[38:39], v18 offset:1536
  ds_read_b64_tr_b16 v[40:41], v19 offset:0
  ds_read_b64_tr_b16 v[42:43], v19 offset:1536
  ds_read_b64_tr_b16 v[44:45], v20 offset:0
  ds_read_b64_tr_b16 v[46:47], v20 offset:1536
  ds_read_b128 v[32:35], v11 offset:0
  ds_read_b64_tr_b16 v[48:49], v18 offset:6144
  ds_read_b64_tr_b16 v[50:51], v18 offset:7680
  ds_read_b64_tr_b16 v[52:53], v19 offset:6144
  ds_read_b64_tr_b16 v[54:55], v19 offset:7680
  ds_read_b64_tr_b16 v[56:57], v20 offset:6144
  ds_read_b64_tr_b16 v[58:59], v20 offset:7680
  s_waitcnt lgkmcnt(7)
  v_mfma_f32_32x32x16_bf16 v[128:143], v[36:39], v[28:31], v[128:143]
  v_mfma_f32_32x32x16_bf16 v[144:159], v[40:43], v[28:31], v[144:159]
  v_mfma_f32_32x32x16_bf16 v[176:191], v[44:47], v[28:31], v[176:191]
  ds_read_b128 v[28:31], v12 offset:0
  ds_read_b64_tr_b16 v[36:37], v18 offset:12288
  ds_read_b64_tr_b16 v[38:39], v18 offset:13824
  ds_read_b64_tr_b16 v[40:41], v19 offset:12288
  ds_read_b64_tr_b16 v[42:43], v19 offset:13824
  ds_read_b64_tr_b16 v[44:45], v20 offset:12288
  ds_read_b64_tr_b16 v[46:47], v20 offset:13824
  s_waitcnt lgkmcnt(7)
  v_mfma_f32_32x32x16_bf16 v[128:143], v[48:51], v[32:35], v[128:143]
  v_mfma_f32_32x32x16_bf16 v[144:159], v[52:55], v[32:35], v[144:159]
  v_mfma_f32_32x32x16_bf16 v[176:191], v[56:59], v[32:35], v[176:191]
  ds_read_b128 v[32:35], v13 offset:0
  ds_read_b64_tr_b16 v[48:49], v18 offset:18432
  ds_read_b64_tr_b16 v[50:51], v18 offset:19968
  ds_read_b64_tr_b16 v[52:53], v19 offset:18432
  ds_read_b64_tr_b16 v[54:55], v19 offset:19968
  ds_read_b64_tr_b16 v[56:57], v20 offset:18432
  ds_read_b64_tr_b16 v[58:59], v20 offset:19968
  s_waitcnt lgkmcnt(7)
  v_mfma_f32_32x32x16_bf16 v[128:143], v[36:39], v[28:31], v[128:143]
  v_mfma_f32_32x32x16_bf16 v[144:159], v[40:43], v[28:31], v[144:159]
  v_mfma_f32_32x32x16_bf16 v[176:191], v[44:47], v[28:31], v[176:191]
  s_waitcnt lgkmcnt(0)
  v_mfma_f32_32x32x16_bf16 v[128:143], v[48:51], v[32:35], v[128:143]
  v_mfma_f32_32x32x16_bf16 v[144:159], v[52:55], v[32:35], v[144:159]
  v_mfma_f32_32x32x16_bf16 v[176:191], v[56:59], v[32:35], v[176:191]
  s_barrier
  ds_read_b128 v[28:31], v10 offset:32768
  ds_read_b64_tr_b16 v[36:37], v18 offset:32768
  ds_read_b64_tr_b16 v[38:39], v18 offset:34304
  ds_read_b64_tr_b16 v[40:41], v19 offset:32768
  ds_read_b64_tr_b16 v[42:43], v19 offset:34304
  ds_read_b64_tr_b16 v[44:45], v20 offset:32768
  ds_read_b64_tr_b16 v[46:47], v20 offset:34304
  ds_read_b128 v[32:35], v11 offset:32768
  ds_read_b64_tr_b16 v[48:49], v18 offset:38912
  ds_read_b64_tr_b16 v[50:51], v18 offset:40448
  ds_read_b64_tr_b16 v[52:53], v19 offset:38912
  ds_read_b64_tr_b16 v[54:55], v19 offset:40448
  ds_read_b64_tr_b16 v[56:57], v20 offset:38912
  ds_read_b64_tr_b16 v[58:59], v20 offset:40448
  s_waitcnt lgkmcnt(7)
  v_mfma_f32_32x32x16_bf16 v[128:143], v[36:39], v[28:31], v[128:143]
  v_mfma_f32_32x32x16_bf16 v[144:159], v[40:43], v[28:31], v[144:159]
  v_mfma_f32_32x32x16_bf16 v[176:191], v[44:47], v[28:31], v[176:191]
  ds_read_b128 v[28:31], v12 offset:32768
  ds_read_b64_tr_b16 v[36:37], v18 offset:45056
  ds_read_b64_tr_b16 v[38:39], v18 offset:46592
  ds_read_b64_tr_b16 v[40:41], v19 offset:45056
  ds_read_b64_tr_b16 v[42:43], v19 offset:46592
  ds_read_b64_tr_b16 v[44:45], v20 offset:45056
  ds_read_b64_tr_b16 v[46:47], v20 offset:46592
  s_waitcnt lgkmcnt(7)
  v_mfma_f32_32x32x16_bf16 v[128:143], v[48:51], v[32:35], v[128:143]
  v_mfma_f32_32x32x16_bf16 v[144:159], v[52:55], v[32:35], v[144:159]
  v_mfma_f32_32x32x16_bf16 v[176:191], v[56:59], v[32:35], v[176:191]
  ds_read_b128 v[32:35], v13 offset:32768
  ds_read_b64_tr_b16 v[48:49], v18 offset:51200
  ds_read_b64_tr_b16 v[50:51], v18 offset:52736
  ds_read_b64_tr_b16 v[52:53], v19 offset:51200
  ds_read_b64_tr_b16 v[54:55], v19 offset:52736
  ds_read_b64_tr_b16 v[56:57], v20 offset:51200
  ds_read_b64_tr_b16 v[58:59], v20 offset:52736
  s_waitcnt lgkmcnt(7)
  v_mfma_f32_32x32x16_bf16 v[128:143], v[36:39], v[28:31], v[128:143]
  v_mfma_f32_32x32x16_bf16 v[144:159], v[40:43], v[28:31], v[144:159]
  v_mfma_f32_32x32x16_bf16 v[176:191], v[44:47], v[28:31], v[176:191]
  s_waitcnt lgkmcnt(0)
  v_mfma_f32_32x32x16_bf16 v[128:143], v[48:51], v[32:35], v[128:143]
  v_mfma_f32_32x32x16_bf16 v[144:159], v[52:55], v[32:35], v[144:159]
  v_mfma_f32_32x32x16_bf16 v[176:191], v[56:59], v[32:35], v[176:191]
  s_barrier
  ds_read_b128 v[28:31], v14 offset:0
  ds_read_b64_tr_b16 v[36:37], v21 offset:0
  ds_read_b64_tr_b16 v[38:39], v21 offset:1536
  ds_read_b64_tr_b16 v[40:41], v22 offset:0
  ds_read_b64_tr_b16 v[42:43], v22 offset:1536
  ds_read_b64_tr_b16 v[44:45], v23 offset:0
  ds_read_b64_tr_b16 v[46:47], v23 offset:1536
  ds_read_b128 v[32:35], v15 offset:0
  ds_read_b64_tr_b16 v[48:49], v21 offset:6144
  ds_read_b64_tr_b16 v[50:51], v21 offset:7680
  ds_read_b64_tr_b16 v[52:53], v22 offset:6144
  ds_read_b64_tr_b16 v[54:55], v22 offset:7680
  ds_read_b64_tr_b16 v[56:57], v23 offset:6144
  ds_read_b64_tr_b16 v[58:59], v23 offset:7680
  s_waitcnt lgkmcnt(7)
  v_mfma_f32_32x32x16_bf16 v[128:143], v[36:39], v[28:31], v[128:143]
  v_mfma_f32_32x32x16_bf16 v[144:159], v[40:43], v[28:31], v[144:159]
  v_mfma_f32_32x32x16_bf16 v[176:191], v[44:47], v[28:31], v[176:191]
  ds_read_b128 v[28:31], v16 offset:0
  ds_read_b64_tr_b16 v[36:37], v21 offset:12288
  ds_read_b64_tr_b16 v[38:39], v21 offset:13824
  ds_read_b64_tr_b16 v[40:41], v22 offset:12288
  ds_read_b64_tr_b16 v[42:43], v22 offset:13824
  ds_read_b64_tr_b16 v[44:45], v23 offset:12288
  ds_read_b64_tr_b16 v[46:47], v23 offset:13824
  s_waitcnt lgkmcnt(7)
  v_mfma_f32_32x32x16_bf16 v[128:143], v[48:51], v[32:35], v[128:143]
  v_mfma_f32_32x32x16_bf16 v[144:159], v[52:55], v[32:35], v[144:159]
  v_mfma_f32_32x32x16_bf16 v[176:191], v[56:59], v[32:35], v[176:191]
  ds_read_b128 v[32:35], v17 offset:0
  ds_read_b64_tr_b16 v[48:49], v21 offset:18432
  ds_read_b64_tr_b16 v[50:51], v21 offset:19968
  ds_read_b64_tr_b16 v[52:53], v22 offset:18432
  ds_read_b64_tr_b16 v[54:55], v22 offset:19968
  ds_read_b64_tr_b16 v[56:57], v23 offset:18432
  ds_read_b64_tr_b16 v[58:59], v23 offset:19968
  s_waitcnt lgkmcnt(7)
  v_mfma_f32_32x32x16_bf16 v[128:143], v[36:39], v[28:31], v[128:143]
  v_mfma_f32_32x32x16_bf16 v[144:159], v[40:43], v[28:31], v[144:159]
  v_mfma_f32_32x32x16_bf16 v[176:191], v[44:47], v[28:31], v[176:191]
  s_waitcnt lgkmcnt(0)
  v_mfma_f32_32x32x16_bf16 v[128:143], v[48:51], v[32:35], v[128:143]
  v_mfma_f32_32x32x16_bf16 v[144:159], v[52:55], v[32:35], v[144:159]
  v_mfma_f32_32x32x16_bf16 v[176:191], v[56:59], v[32:35], v[176:191]
  s_barrier
  ds_read_b128 v[28:31], v14 offset:32768
  ds_read_b64_tr_b16 v[36:37], v21 offset:32768
  ds_read_b64_tr_b16 v[38:39], v21 offset:34304
  ds_read_b64_tr_b16 v[40:41], v22 offset:32768
  ds_read_b64_tr_b16 v[42:43], v22 offset:34304
  ds_read_b64_tr_b16 v[44:45], v23 offset:32768
  ds_read_b64_tr_b16 v[46:47], v23 offset:34304
  ds_read_b128 v[32:35], v15 offset:32768
  ds_read_b64_tr_b16 v[48:49], v21 offset:38912
  ds_read_b64_tr_b16 v[50:51], v21 offset:40448
  ds_read_b64_tr_b16 v[52:53], v22 offset:38912
  ds_read_b64_tr_b16 v[54:55], v22 offset:40448
  ds_read_b64_tr_b16 v[56:57], v23 offset:38912
  ds_read_b64_tr_b16 v[58:59], v23 offset:40448
  s_waitcnt lgkmcnt(7)
  v_mfma_f32_32x32x16_bf16 v[128:143], v[36:39], v[28:31], v[128:143]
  v_mfma_f32_32x32x16_bf16 v[144:159], v[40:43], v[28:31], v[144:159]
  v_mfma_f32_32x32x16_bf16 v[176:191], v[44:47], v[28:31], v[176:191]
  ds_read_b128 v[28:31], v16 offset:32768
  ds_read_b64_tr_b16 v[36:37], v21 offset:45056
  ds_read_b64_tr_b16 v[38:39], v21 offset:46592
  ds_read_b64_tr_b16 v[40:41], v22 offset:45056
  ds_read_b64_tr_b16 v[42:43], v22 offset:46592
  ds_read_b64_tr_b16 v[44:45], v23 offset:45056
  ds_read_b64_tr_b16 v[46:47], v23 offset:46592
  s_waitcnt lgkmcnt(7)
  v_mfma_f32_32x32x16_bf16 v[128:143], v[48:51], v[32:35], v[128:143]
  v_mfma_f32_32x32x16_bf16 v[144:159], v[52:55], v[32:35], v[144:159]
  v_mfma_f32_32x32x16_bf16 v[176:191], v[56:59], v[32:35], v[176:191]
  ds_read_b128 v[32:35], v17 offset:32768
  ds_read_b64_tr_b16 v[48:49], v21 offset:51200
  ds_read_b64_tr_b16 v[50:51], v21 offset:52736
  ds_read_b64_tr_b16 v[52:53], v22 offset:51200
  ds_read_b64_tr_b16 v[54:55], v22 offset:52736
  ds_read_b64_tr_b16 v[56:57], v23 offset:51200
  ds_read_b64_tr_b16 v[58:59], v23 offset:52736
  s_waitcnt lgkmcnt(7)
  v_mfma_f32_32x32x16_bf16 v[128:143], v[36:39], v[28:31], v[128:143]
  v_mfma_f32_32x32x16_bf16 v[144:159], v[40:43], v[28:31], v[144:159]
  v_mfma_f32_32x32x16_bf16 v[176:191], v[44:47], v[28:31], v[176:191]
  s_waitcnt lgkmcnt(0)
  v_mfma_f32_32x32x16_bf16 v[128:143], v[48:51], v[32:35], v[128:143]
  v_mfma_f32_32x32x16_bf16 v[144:159], v[52:55], v[32:35], v[144:159]
  v_mfma_f32_32x32x16_bf16 v[176:191], v[56:59], v[32:35], v[176:191]
  s_nop 15
  v_mul_f32 v128, s55, v128
  v_mul_f32 v129, s55, v129
  v_mul_f32 v130, s55, v130
  v_mul_f32 v131, s55, v131
  v_mul_f32 v132, s55, v132
  v_mul_f32 v133, s55, v133
  v_mul_f32 v134, s55, v134
  v_mul_f32 v135, s55, v135
  v_cvt_pk_bf16_f32 v112, v128, v129
  v_cvt_pk_bf16_f32 v113, v130, v131
  v_cvt_pk_bf16_f32 v114, v132, v133
  v_cvt_pk_bf16_f32 v115, v134, v135
  s_add_u32 s59, s52, 6291456
  s_add_u32 s59, s59, s53
  buffer_store_dwordx4 v[112:115], v24, s[4:7], s59 offen sc1
  v_mul_f32 v136, s55, v136
  v_mul_f32 v137, s55, v137
  v_mul_f32 v138, s55, v138
  v_mul_f32 v139, s55, v139
  v_mul_f32 v140, s55, v140
  v_mul_f32 v141, s55, v141
  v_mul_f32 v142, s55, v142
  v_mul_f32 v143, s55, v143
  v_cvt_pk_bf16_f32 v116, v136, v137
  v_cvt_pk_bf16_f32 v117, v138, v139
  v_cvt_pk_bf16_f32 v118, v140, v141
  v_cvt_pk_bf16_f32 v119, v142, v143
  s_add_u32 s59, s52, 6488064
  s_add_u32 s59, s59, s53
  buffer_store_dwordx4 v[116:119], v24, s[4:7], s59 offen sc1
  v_mul_f32 v144, s55, v144
  v_mul_f32 v145, s55, v145
  v_mul_f32 v146, s55, v146
  v_mul_f32 v147, s55, v147
  v_mul_f32 v148, s55, v148
  v_mul_f32 v149, s55, v149
  v_mul_f32 v150, s55, v150
  v_mul_f32 v151, s55, v151
  v_cvt_pk_bf16_f32 v120, v144, v145
  v_cvt_pk_bf16_f32 v121, v146, v147
  v_cvt_pk_bf16_f32 v122, v148, v149
  v_cvt_pk_bf16_f32 v123, v150, v151
  s_add_u32 s59, s52, 6684672
  s_add_u32 s59, s59, s53
  buffer_store_dwordx4 v[120:123], v24, s[4:7], s59 offen sc1
  v_mul_f32 v152, s55, v152
  v_mul_f32 v153, s55, v153
  v_mul_f32 v154, s55, v154
  v_mul_f32 v155, s55, v155
  v_mul_f32 v156, s55, v156
  v_mul_f32 v157, s55, v157
  v_mul_f32 v158, s55, v158
  v_mul_f32 v159, s55, v159
  v_cvt_pk_bf16_f32 v124, v152, v153
  v_cvt_pk_bf16_f32 v125, v154, v155
  v_cvt_pk_bf16_f32 v126, v156, v157
  v_cvt_pk_bf16_f32 v127, v158, v159
  s_add_u32 s59, s52, 6881280
  s_add_u32 s59, s59, s53
  buffer_store_dwordx4 v[124:127], v24, s[4:7], s59 offen sc1
  v_cvt_pk_bf16_f32 v112, v176, v177
  v_cvt_pk_bf16_f32 v113, v178, v179
  v_cvt_pk_bf16_f32 v114, v180, v181
  v_cvt_pk_bf16_f32 v115, v182, v183
  s_add_u32 s59, s52, 6291456
  s_add_u32 s59, s59, s54
  buffer_store_dwordx4 v[112:115], v24, s[4:7], s59 offen sc1
  v_cvt_pk_bf16_f32 v116, v184, v185
  v_cvt_pk_bf16_f32 v117, v186, v187
  v_cvt_pk_bf16_f32 v118, v188, v189
  v_cvt_pk_bf16_f32 v119, v190, v191
  s_add_u32 s59, s52, 6488064
  s_add_u32 s59, s59, s54
  buffer_store_dwordx4 v[116:119], v24, s[4:7], s59 offen sc1
  s_branch Lfa_attn
Lfa_wn1:
  s_mov_b32 s57, 0
Lpj1_loop:
  s_barrier
  ds_read_b128 v[28:31], v10 offset:0
  ds_read_b64_tr_b16 v[36:37], v18 offset:0
  ds_read_b64_tr_b16 v[38:39], v18 offset:1536
  ds_read_b64_tr_b16 v[40:41], v19 offset:0
  ds_read_b64_tr_b16 v[42:43], v19 offset:1536
  ds_read_b64_tr_b16 v[44:45], v20 offset:0
  ds_read_b64_tr_b16 v[46:47], v20 offset:1536
  ds_read_b128 v[32:35], v11 offset:0
  ds_read_b64_tr_b16 v[48:49], v18 offset:6144
  ds_read_b64_tr_b16 v[50:51], v18 offset:7680
  ds_read_b64_tr_b16 v[52:53], v19 offset:6144
  ds_read_b64_tr_b16 v[54:55], v19 offset:7680
  ds_read_b64_tr_b16 v[56:57], v20 offset:6144
  ds_read_b64_tr_b16 v[58:59], v20 offset:7680
  s_waitcnt lgkmcnt(7)
  v_mfma_f32_32x32x16_bf16 v[64:79], v[36:39], v[28:31], v[64:79]
  v_mfma_f32_32x32x16_bf16 v[80:95], v[28:31], v[40:43], v[80:95]
  v_mfma_f32_32x32x16_bf16 v[96:111], v[28:31], v[44:47], v[96:111]
  ds_read_b128 v[28:31], v12 offset:0
  ds_read_b64_tr_b16 v[36:37], v18 offset:12288
  ds_read_b64_tr_b16 v[38:39], v18 offset:13824
  ds_read_b64_tr_b16 v[40:41], v19 offset:12288
  ds_read_b64_tr_b16 v[42:43], v19 offset:13824
  ds_read_b64_tr_b16 v[44:45], v20 offset:12288
  ds_read_b64_tr_b16 v[46:47], v20 offset:13824
  s_waitcnt lgkmcnt(7)
  v_mfma_f32_32x32x16_bf16 v[64:79], v[48:51], v[32:35], v[64:79]
  v_mfma_f32_32x32x16_bf16 v[80:95], v[32:35], v[52:55], v[80:95]
  v_mfma_f32_32x32x16_bf16 v[96:111], v[32:35], v[56:59], v[96:111]
  ds_read_b128 v[32:35], v13 offset:0
  ds_read_b64_tr_b16 v[48:49], v18 offset:18432
  ds_read_b64_tr_b16 v[50:51], v18 offset:19968
  ds_read_b64_tr_b16 v[52:53], v19 offset:18432
  ds_read_b64_tr_b16 v[54:55], v19 offset:19968
  ds_read_b64_tr_b16 v[56:57], v20 offset:18432
  ds_read_b64_tr_b16 v[58:59], v20 offset:19968
  s_waitcnt lgkmcnt(7)
  v_mfma_f32_32x32x16_bf16 v[64:79], v[36:39], v[28:31], v[64:79]
  v_mfma_f32_32x32x16_bf16 v[80:95], v[28:31], v[40:43], v[80:95]
  v_mfma_f32_32x32x16_bf16 v[96:111], v[28:31], v[44:47], v[96:111]
  s_waitcnt lgkmcnt(0)
  v_mfma_f32_32x32x16_bf16 v[64:79], v[48:51], v[32:35], v[64:79]
  v_mfma_f32_32x32x16_bf16 v[80:95], v[32:35], v[52:55], v[80:95]
  v_mfma_f32_32x32x16_bf16 v[96:111], v[32:35], v[56:59], v[96:111]
  s_barrier
  ds_read_b128 v[28:31], v10 offset:32768
  ds_read_b64_tr_b16 v[36:37], v18 offset:32768
  ds_read_b64_tr_b16 v[38:39], v18 offset:34304
  ds_read_b64_tr_b16 v[40:41], v19 offset:32768
  ds_read_b64_tr_b16 v[42:43], v19 offset:34304
  ds_read_b64_tr_b16 v[44:45], v20 offset:32768
  ds_read_b64_tr_b16 v[46:47], v20 offset:34304
  ds_read_b128 v[32:35], v11 offset:32768
  ds_read_b64_tr_b16 v[48:49], v18 offset:38912
  ds_read_b64_tr_b16 v[50:51], v18 offset:40448
  ds_read_b64_tr_b16 v[52:53], v19 offset:38912
  ds_read_b64_tr_b16 v[54:55], v19 offset:40448
  ds_read_b64_tr_b16 v[56:57], v20 offset:38912
  ds_read_b64_tr_b16 v[58:59], v20 offset:40448
  s_waitcnt lgkmcnt(7)
  v_mfma_f32_32x32x16_bf16 v[64:79], v[36:39], v[28:31], v[64:79]
  v_mfma_f32_32x32x16_bf16 v[80:95], v[28:31], v[40:43], v[80:95]
  v_mfma_f32_32x32x16_bf16 v[96:111], v[28:31], v[44:47], v[96:111]
  ds_read_b128 v[28:31], v12 offset:32768
  ds_read_b64_tr_b16 v[36:37], v18 offset:45056
  ds_read_b64_tr_b16 v[38:39], v18 offset:46592
  ds_read_b64_tr_b16 v[40:41], v19 offset:45056
  ds_read_b64_tr_b16 v[42:43], v19 offset:46592
  ds_read_b64_tr_b16 v[44:45], v20 offset:45056
  ds_read_b64_tr_b16 v[46:47], v20 offset:46592
  s_waitcnt lgkmcnt(7)
  v_mfma_f32_32x32x16_bf16 v[64:79], v[48:51], v[32:35], v[64:79]
  v_mfma_f32_32x32x16_bf16 v[80:95], v[32:35], v[52:55], v[80:95]
  v_mfma_f32_32x32x16_bf16 v[96:111], v[32:35], v[56:59], v[96:111]
  ds_read_b128 v[32:35], v13 offset:32768
  ds_read_b64_tr_b16 v[48:49], v18 offset:51200
  ds_read_b64_tr_b16 v[50:51], v18 offset:52736
  ds_read_b64_tr_b16 v[52:53], v19 offset:51200
  ds_read_b64_tr_b16 v[54:55], v19 offset:52736
  ds_read_b64_tr_b16 v[56:57], v20 offset:51200
  ds_read_b64_tr_b16 v[58:59], v20 offset:52736
  s_waitcnt lgkmcnt(7)
  v_mfma_f32_32x32x16_bf16 v[64:79], v[36:39], v[28:31], v[64:79]
  v_mfma_f32_32x32x16_bf16 v[80:95], v[28:31], v[40:43], v[80:95]
  v_mfma_f32_32x32x16_bf16 v[96:111], v[28:31], v[44:47], v[96:111]
  s_waitcnt lgkmcnt(0)
  v_mfma_f32_32x32x16_bf16 v[64:79], v[48:51], v[32:35], v[64:79]
  v_mfma_f32_32x32x16_bf16 v[80:95], v[32:35], v[52:55], v[80:95]
  v_mfma_f32_32x32x16_bf16 v[96:111], v[32:35], v[56:59], v[96:111]
  s_barrier
  ds_read_b128 v[28:31], v14 offset:0
  ds_read_b64_tr_b16 v[36:37], v21 offset:0
  ds_read_b64_tr_b16 v[38:39], v21 offset:1536
  ds_read_b64_tr_b16 v[40:41], v22 offset:0
  ds_read_b64_tr_b16 v[42:43], v22 offset:1536
  ds_read_b64_tr_b16 v[44:45], v23 offset:0
  ds_read_b64_tr_b16 v[46:47], v23 offset:1536
  ds_read_b128 v[32:35], v15 offset:0
  ds_read_b64_tr_b16 v[48:49], v21 offset:6144
  ds_read_b64_tr_b16 v[50:51], v21 offset:7680
  ds_read_b64_tr_b16 v[52:53], v22 offset:6144
  ds_read_b64_tr_b16 v[54:55], v22 offset:7680
  ds_read_b64_tr_b16 v[56:57], v23 offset:6144
  ds_read_b64_tr_b16 v[58:59], v23 offset:7680
  s_waitcnt lgkmcnt(7)
  v_mfma_f32_32x32x16_bf16 v[64:79], v[36:39], v[28:31], v[64:79]
  v_mfma_f32_32x32x16_bf16 v[80:95], v[28:31], v[40:43], v[80:95]
  v_mfma_f32_32x32x16_bf16 v[96:111], v[28:31], v[44:47], v[96:111]
  ds_read_b128 v[28:31], v16 offset:0
  ds_read_b64_tr_b16 v[36:37], v21 offset:12288
  ds_read_b64_tr_b16 v[38:39], v21 offset:13824
  ds_read_b64_tr_b16 v[40:41], v22 offset:12288
  ds_read_b64_tr_b16 v[42:43], v22 offset:13824
  ds_read_b64_tr_b16 v[44:45], v23 offset:12288
  ds_read_b64_tr_b16 v[46:47], v23 offset:13824
  s_waitcnt lgkmcnt(7)
  v_mfma_f32_32x32x16_bf16 v[64:79], v[48:51], v[32:35], v[64:79]
  v_mfma_f32_32x32x16_bf16 v[80:95], v[32:35], v[52:55], v[80:95]
  v_mfma_f32_32x32x16_bf16 v[96:111], v[32:35], v[56:59], v[96:111]
  ds_read_b128 v[32:35], v17 offset:0
  ds_read_b64_tr_b16 v[48:49], v21 offset:18432
  ds_read_b64_tr_b16 v[50:51], v21 offset:19968
  ds_read_b64_tr_b16 v[52:53], v22 offset:18432
  ds_read_b64_tr_b16 v[54:55], v22 offset:19968
  ds_read_b64_tr_b16 v[56:57], v23 offset:18432
  ds_read_b64_tr_b16 v[58:59], v23 offset:19968
  s_waitcnt lgkmcnt(7)
  v_mfma_f32_32x32x16_bf16 v[64:79], v[36:39], v[28:31], v[64:79]
  v_mfma_f32_32x32x16_bf16 v[80:95], v[28:31], v[40:43], v[80:95]
  v_mfma_f32_32x32x16_bf16 v[96:111], v[28:31], v[44:47], v[96:111]
  s_waitcnt lgkmcnt(0)
  v_mfma_f32_32x32x16_bf16 v[64:79], v[48:51], v[32:35], v[64:79]
  v_mfma_f32_32x32x16_bf16 v[80:95], v[32:35], v[52:55], v[80:95]
  v_mfma_f32_32x32x16_bf16 v[96:111], v[32:35], v[56:59], v[96:111]
  s_barrier
  ds_read_b128 v[28:31], v14 offset:32768
  ds_read_b64_tr_b16 v[36:37], v21 offset:32768
  ds_read_b64_tr_b16 v[38:39], v21 offset:34304
  ds_read_b64_tr_b16 v[40:41], v22 offset:32768
  ds_read_b64_tr_b16 v[42:43], v22 offset:34304
  ds_read_b64_tr_b16 v[44:45], v23 offset:32768
  ds_read_b64_tr_b16 v[46:47], v23 offset:34304
  ds_read_b128 v[32:35], v15 offset:32768
  ds_read_b64_tr_b16 v[48:49], v21 offset:38912
  ds_read_b64_tr_b16 v[50:51], v21 offset:40448
  ds_read_b64_tr_b16 v[52:53], v22 offset:38912
  ds_read_b64_tr_b16 v[54:55], v22 offset:40448
  ds_read_b64_tr_b16 v[56:57], v23 offset:38912
  ds_read_b64_tr_b16 v[58:59], v23 offset:40448
  s_waitcnt lgkmcnt(7)
  v_mfma_f32_32x32x16_bf16 v[64:79], v[36:39], v[28:31], v[64:79]
  v_mfma_f32_32x32x16_bf16 v[80:95], v[28:31], v[40:43], v[80:95]
  v_mfma_f32_32x32x16_bf16 v[96:111], v[28:31], v[44:47], v[96:111]
  ds_read_b128 v[28:31], v16 offset:32768
  ds_read_b64_tr_b16 v[36:37], v21 offset:45056
  ds_read_b64_tr_b16 v[38:39], v21 offset:46592
  ds_read_b64_tr_b16 v[40:41], v22 offset:45056
  ds_read_b64_tr_b16 v[42:43], v22 offset:46592
  ds_read_b64_tr_b16 v[44:45], v23 offset:45056
  ds_read_b64_tr_b16 v[46:47], v23 offset:46592
  s_waitcnt lgkmcnt(7)
  v_mfma_f32_32x32x16_bf16 v[64:79], v[48:51], v[32:35], v[64:79]
  v_mfma_f32_32x32x16_bf16 v[80:95], v[32:35], v[52:55], v[80:95]
  v_mfma_f32_32x32x16_bf16 v[96:111], v[32:35], v[56:59], v[96:111]
  ds_read_b128 v[32:35], v17 offset:32768
  ds_read_b64_tr_b16 v[48:49], v21 offset:51200
  ds_read_b64_tr_b16 v[50:51], v21 offset:52736
  ds_read_b64_tr_b16 v[52:53], v22 offset:51200
  ds_read_b64_tr_b16 v[54:55], v22 offset:52736
  ds_read_b64_tr_b16 v[56:57], v23 offset:51200
  ds_read_b64_tr_b16 v[58:59], v23 offset:52736
  s_waitcnt lgkmcnt(7)
  v_mfma_f32_32x32x16_bf16 v[64:79], v[36:39], v[28:31], v[64:79]
  v_mfma_f32_32x32x16_bf16 v[80:95], v[28:31], v[40:43], v[80:95]
  v_mfma_f32_32x32x16_bf16 v[96:111], v[28:31], v[44:47], v[96:111]
  s_waitcnt lgkmcnt(0)
  v_mfma_f32_32x32x16_bf16 v[64:79], v[48:51], v[32:35], v[64:79]
  v_mfma_f32_32x32x16_bf16 v[80:95], v[32:35], v[52:55], v[80:95]
  v_mfma_f32_32x32x16_bf16 v[96:111], v[32:35], v[56:59], v[96:111]
  s_add_u32 s57, s57, 1
  s_cmp_lt_u32 s57, 2
  s_cbranch_scc1 Lpj1_loop
  s_barrier
  v_add_u32 v10, 131072, v10
  v_add_u32 v11, 131072, v11
  v_add_u32 v12, 131072, v12
  v_add_u32 v13, 131072, v13
  v_add_u32 v18, 131072, v18
  v_add_u32 v19, 131072, v19
  v_add_u32 v20, 131072, v20
  s_nop 7
  ds_read_b128 v[28:31], v10 offset:0
  ds_read_b64_tr_b16 v[36:37], v18 offset:0
  ds_read_b64_tr_b16 v[38:39], v18 offset:1536
  ds_read_b64_tr_b16 v[40:41], v19 offset:0
  ds_read_b64_tr_b16 v[42:43], v19 offset:1536
  ds_read_b64_tr_b16 v[44:45], v20 offset:0
  ds_read_b64_tr_b16 v[46:47], v20 offset:1536
  ds_read_b128 v[32:35], v11 offset:0
  ds_read_b64_tr_b16 v[48:49], v18 offset:6144
  ds_read_b64_tr_b16 v[50:51], v18 offset:7680
  ds_read_b64_tr_b16 v[52:53], v19 offset:6144
  ds_read_b64_tr_b16 v[54:55], v19 offset:7680
  ds_read_b64_tr_b16 v[56:57], v20 offset:6144
  ds_read_b64_tr_b16 v[58:59], v20 offset:7680
  s_waitcnt lgkmcnt(7)
  v_mfma_f32_32x32x16_bf16 v[128:143], v[36:39], v[28:31], 0
  v_mfma_f32_32x32x16_bf16 v[144:159], v[28:31], v[40:43], 0
  v_mfma_f32_32x32x16_bf16 v[176:191], v[28:31], v[44:47], 0
  v_cvt_pk_bf16_f32 v112, v64, v65
  v_cvt_pk_bf16_f32 v113, v66, v67
  v_cvt_pk_bf16_f32 v114, v68, v69
  v_cvt_pk_bf16_f32 v115, v70, v71
  s_add_u32 s59, s52, 393216
  s_add_u32 s59, s59, s54
  buffer_store_dwordx4 v[112:115], v24, s[4:7], s59 offen sc1
  v_cvt_pk_bf16_f32 v116, v72, v73
  v_cvt_pk_bf16_f32 v117, v74, v75
  v_cvt_pk_bf16_f32 v118, v76, v77
  v_cvt_pk_bf16_f32 v119, v78, v79
  s_add_u32 s59, s52, 589824
  s_add_u32 s59, s59, s54
  buffer_store_dwordx4 v[116:119], v24, s[4:7], s59 offen sc1
  ds_read_b128 v[28:31], v12 offset:0
  ds_read_b64_tr_b16 v[36:37], v18 offset:12288
  ds_read_b64_tr_b16 v[38:39], v18 offset:13824
  ds_read_b64_tr_b16 v[40:41], v19 offset:12288
  ds_read_b64_tr_b16 v[42:43], v19 offset:13824
  ds_read_b64_tr_b16 v[44:45], v20 offset:12288
  ds_read_b64_tr_b16 v[46:47], v20 offset:13824
  s_waitcnt lgkmcnt(7)
  v_mfma_f32_32x32x16_bf16 v[128:143], v[48:51], v[32:35], v[128:143]
  v_mfma_f32_32x32x16_bf16 v[144:159], v[32:35], v[52:55], v[144:159]
  v_mfma_f32_32x32x16_bf16 v[176:191], v[32:35], v[56:59], v[176:191]
  v_cvt_pk_bf16_f32 v120, v80, v81
  v_cvt_pk_bf16_f32 v121, v82, v83
  v_cvt_pk_bf16_f32 v122, v84, v85
  v_cvt_pk_bf16_f32 v123, v86, v87
  s_add_u32 s59, s52, 1024
  s_add_u32 s59, s59, s54
  buffer_store_dwordx4 v[120:123], v25, s[4:7], s59 offen sc1
  v_cvt_pk_bf16_f32 v124, v88, v89
  v_cvt_pk_bf16_f32 v125, v90, v91
  v_cvt_pk_bf16_f32 v126, v92, v93
  v_cvt_pk_bf16_f32 v127, v94, v95
  s_add_u32 s59, s52, 1536
  s_add_u32 s59, s59, s54
  buffer_store_dwordx4 v[124:127], v25, s[4:7], s59 offen sc1
  ds_read_b128 v[32:35], v13 offset:0
  ds_read_b64_tr_b16 v[48:49], v18 offset:18432
  ds_read_b64_tr_b16 v[50:51], v18 offset:19968
  ds_read_b64_tr_b16 v[52:53], v19 offset:18432
  ds_read_b64_tr_b16 v[54:55], v19 offset:19968
  ds_read_b64_tr_b16 v[56:57], v20 offset:18432
  ds_read_b64_tr_b16 v[58:59], v20 offset:19968
  s_waitcnt lgkmcnt(7)
  v_mfma_f32_32x32x16_bf16 v[128:143], v[36:39], v[28:31], v[128:143]
  v_mfma_f32_32x32x16_bf16 v[144:159], v[28:31], v[40:43], v[144:159]
  v_mfma_f32_32x32x16_bf16 v[176:191], v[28:31], v[44:47], v[176:191]
  v_cvt_pk_bf16_f32 v112, v96, v97
  v_cvt_pk_bf16_f32 v113, v98, v99
  v_cvt_pk_bf16_f32 v114, v100, v101
  v_cvt_pk_bf16_f32 v115, v102, v103
  s_add_u32 s59, s52, 394240
  s_add_u32 s59, s59, s54
  buffer_store_dwordx4 v[112:115], v25, s[4:7], s59 offen sc1
  v_cvt_pk_bf16_f32 v116, v104, v105
  v_cvt_pk_bf16_f32 v117, v106, v107
  v_cvt_pk_bf16_f32 v118, v108, v109
  v_cvt_pk_bf16_f32 v119, v110, v111
  s_add_u32 s59, s52, 394752
  s_add_u32 s59, s59, s54
  buffer_store_dwordx4 v[116:119], v25, s[4:7], s59 offen sc1
  s_waitcnt lgkmcnt(0)
  v_mfma_f32_32x32x16_bf16 v[128:143], v[48:51], v[32:35], v[128:143]
  v_mfma_f32_32x32x16_bf16 v[144:159], v[32:35], v[52:55], v[144:159]
  v_mfma_f32_32x32x16_bf16 v[176:191], v[32:35], v[56:59], v[176:191]
  v_subrev_u32 v10, 131072, v10
  v_subrev_u32 v11, 131072, v11
  v_subrev_u32 v12, 131072, v12
  v_subrev_u32 v13, 131072, v13
  v_subrev_u32 v18, 131072, v18
  v_subrev_u32 v19, 131072, v19
  v_subrev_u32 v20, 131072, v20
  s_barrier
  s_waitcnt vmcnt(0)
  ds_read_b128 v[28:31], v10 offset:32768
  ds_read_b64_tr_b16 v[36:37], v18 offset:32768
  ds_read_b64_tr_b16 v[38:39], v18 offset:34304
  ds_read_b64_tr_b16 v[40:41], v19 offset:32768
  ds_read_b64_tr_b16 v[42:43], v19 offset:34304
  ds_read_b64_tr_b16 v[44:45], v20 offset:32768
  ds_read_b64_tr_b16 v[46:47], v20 offset:34304
  ds_read_b128 v[32:35], v11 offset:32768
  ds_read_b64_tr_b16 v[48:49], v18 offset:38912
  ds_read_b64_tr_b16 v[50:51], v18 offset:40448
  ds_read_b64_tr_b16 v[52:53], v19 offset:38912
  ds_read_b64_tr_b16 v[54:55], v19 offset:40448
  ds_read_b64_tr_b16 v[56:57], v20 offset:38912
  ds_read_b64_tr_b16 v[58:59], v20 offset:40448
  s_waitcnt lgkmcnt(7)
  v_mfma_f32_32x32x16_bf16 v[128:143], v[36:39], v[28:31], v[128:143]
  v_mfma_f32_32x32x16_bf16 v[144:159], v[28:31], v[40:43], v[144:159]
  v_mfma_f32_32x32x16_bf16 v[176:191], v[28:31], v[44:47], v[176:191]
  ds_read_b128 v[28:31], v12 offset:32768
  ds_read_b64_tr_b16 v[36:37], v18 offset:45056
  ds_read_b64_tr_b16 v[38:39], v18 offset:46592
  ds_read_b64_tr_b16 v[40:41], v19 offset:45056
  ds_read_b64_tr_b16 v[42:43], v19 offset:46592
  ds_read_b64_tr_b16 v[44:45], v20 offset:45056
  ds_read_b64_tr_b16 v[46:47], v20 offset:46592
  s_waitcnt lgkmcnt(7)
  v_mfma_f32_32x32x16_bf16 v[128:143], v[48:51], v[32:35], v[128:143]
  v_mfma_f32_32x32x16_bf16 v[144:159], v[32:35], v[52:55], v[144:159]
  v_mfma_f32_32x32x16_bf16 v[176:191], v[32:35], v[56:59], v[176:191]
  ds_read_b128 v[32:35], v13 offset:32768
  ds_read_b64_tr_b16 v[48:49], v18 offset:51200
  ds_read_b64_tr_b16 v[50:51], v18 offset:52736
  ds_read_b64_tr_b16 v[52:53], v19 offset:51200
  ds_read_b64_tr_b16 v[54:55], v19 offset:52736
  ds_read_b64_tr_b16 v[56:57], v20 offset:51200
  ds_read_b64_tr_b16 v[58:59], v20 offset:52736
  s_waitcnt lgkmcnt(7)
  v_mfma_f32_32x32x16_bf16 v[128:143], v[36:39], v[28:31], v[128:143]
  v_mfma_f32_32x32x16_bf16 v[144:159], v[28:31], v[40:43], v[144:159]
  v_mfma_f32_32x32x16_bf16 v[176:191], v[28:31], v[44:47], v[176:191]
  s_waitcnt lgkmcnt(0)
  v_mfma_f32_32x32x16_bf16 v[128:143], v[48:51], v[32:35], v[128:143]
  v_mfma_f32_32x32x16_bf16 v[144:159], v[32:35], v[52:55], v[144:159]
  v_mfma_f32_32x32x16_bf16 v[176:191], v[32:35], v[56:59], v[176:191]
  s_barrier
  ds_read_b128 v[28:31], v14 offset:0
  ds_read_b64_tr_b16 v[36:37], v21 offset:0
  ds_read_b64_tr_b16 v[38:39], v21 offset:1536
  ds_read_b64_tr_b16 v[40:41], v22 offset:0
  ds_read_b64_tr_b16 v[42:43], v22 offset:1536
  ds_read_b64_tr_b16 v[44:45], v23 offset:0
  ds_read_b64_tr_b16 v[46:47], v23 offset:1536
  ds_read_b128 v[32:35], v15 offset:0
  ds_read_b64_tr_b16 v[48:49], v21 offset:6144
  ds_read_b64_tr_b16 v[50:51], v21 offset:7680
  ds_read_b64_tr_b16 v[52:53], v22 offset:6144
  ds_read_b64_tr_b16 v[54:55], v22 offset:7680
  ds_read_b64_tr_b16 v[56:57], v23 offset:6144
  ds_read_b64_tr_b16 v[58:59], v23 offset:7680
  s_waitcnt lgkmcnt(7)
  v_mfma_f32_32x32x16_bf16 v[128:143], v[36:39], v[28:31], v[128:143]
  v_mfma_f32_32x32x16_bf16 v[144:159], v[28:31], v[40:43], v[144:159]
  v_mfma_f32_32x32x16_bf16 v[176:191], v[28:31], v[44:47], v[176:191]
  ds_read_b128 v[28:31], v16 offset:0
  ds_read_b64_tr_b16 v[36:37], v21 offset:12288
  ds_read_b64_tr_b16 v[38:39], v21 offset:13824
  ds_read_b64_tr_b16 v[40:41], v22 offset:12288
  ds_read_b64_tr_b16 v[42:43], v22 offset:13824
  ds_read_b64_tr_b16 v[44:45], v23 offset:12288
  ds_read_b64_tr_b16 v[46:47], v23 offset:13824
  s_waitcnt lgkmcnt(7)
  v_mfma_f32_32x32x16_bf16 v[128:143], v[48:51], v[32:35], v[128:143]
  v_mfma_f32_32x32x16_bf16 v[144:159], v[32:35], v[52:55], v[144:159]
  v_mfma_f32_32x32x16_bf16 v[176:191], v[32:35], v[56:59], v[176:191]
  ds_read_b128 v[32:35], v17 offset:0
  ds_read_b64_tr_b16 v[48:49], v21 offset:18432
  ds_read_b64_tr_b16 v[50:51], v21 offset:19968
  ds_read_b64_tr_b16 v[52:53], v22 offset:18432
  ds_read_b64_tr_b16 v[54:55], v22 offset:19968
  ds_read_b64_tr_b16 v[56:57], v23 offset:18432
  ds_read_b64_tr_b16 v[58:59], v23 offset:19968
  s_waitcnt lgkmcnt(7)
  v_mfma_f32_32x32x16_bf16 v[128:143], v[36:39], v[28:31], v[128:143]
  v_mfma_f32_32x32x16_bf16 v[144:159], v[28:31], v[40:43], v[144:159]
  v_mfma_f32_32x32x16_bf16 v[176:191], v[28:31], v[44:47], v[176:191]
  s_waitcnt lgkmcnt(0)
  v_mfma_f32_32x32x16_bf16 v[128:143], v[48:51], v[32:35], v[128:143]
  v_mfma_f32_32x32x16_bf16 v[144:159], v[32:35], v[52:55], v[144:159]
  v_mfma_f32_32x32x16_bf16 v[176:191], v[32:35], v[56:59], v[176:191]
  s_barrier
  ds_read_b128 v[28:31], v14 offset:32768
  ds_read_b64_tr_b16 v[36:37], v21 offset:32768
  ds_read_b64_tr_b16 v[38:39], v21 offset:34304
  ds_read_b64_tr_b16 v[40:41], v22 offset:32768
  ds_read_b64_tr_b16 v[42:43], v22 offset:34304
  ds_read_b64_tr_b16 v[44:45], v23 offset:32768
  ds_read_b64_tr_b16 v[46:47], v23 offset:34304
  ds_read_b128 v[32:35], v15 offset:32768
  ds_read_b64_tr_b16 v[48:49], v21 offset:38912
  ds_read_b64_tr_b16 v[50:51], v21 offset:40448
  ds_read_b64_tr_b16 v[52:53], v22 offset:38912
  ds_read_b64_tr_b16 v[54:55], v22 offset:40448
  ds_read_b64_tr_b16 v[56:57], v23 offset:38912
  ds_read_b64_tr_b16 v[58:59], v23 offset:40448
  s_waitcnt lgkmcnt(7)
  v_mfma_f32_32x32x16_bf16 v[128:143], v[36:39], v[28:31], v[128:143]
  v_mfma_f32_32x32x16_bf16 v[144:159], v[28:31], v[40:43], v[144:159]
  v_mfma_f32_32x32x16_bf16 v[176:191], v[28:31], v[44:47], v[176:191]
  ds_read_b128 v[28:31], v16 offset:32768
  ds_read_b64_tr_b16 v[36:37], v21 offset:45056
  ds_read_b64_tr_b16 v[38:39], v21 offset:46592
  ds_read_b64_tr_b16 v[40:41], v22 offset:45056
  ds_read_b64_tr_b16 v[42:43], v22 offset:46592
  ds_read_b64_tr_b16 v[44:45], v23 offset:45056
  ds_read_b64_tr_b16 v[46:47], v23 offset:46592
  s_waitcnt lgkmcnt(7)
  v_mfma_f32_32x32x16_bf16 v[128:143], v[48:51], v[32:35], v[128:143]
  v_mfma_f32_32x32x16_bf16 v[144:159], v[32:35], v[52:55], v[144:159]
  v_mfma_f32_32x32x16_bf16 v[176:191], v[32:35], v[56:59], v[176:191]
  ds_read_b128 v[32:35], v17 offset:32768
  ds_read_b64_tr_b16 v[48:49], v21 offset:51200
  ds_read_b64_tr_b16 v[50:51], v21 offset:52736
  ds_read_b64_tr_b16 v[52:53], v22 offset:51200
  ds_read_b64_tr_b16 v[54:55], v22 offset:52736
  ds_read_b64_tr_b16 v[56:57], v23 offset:51200
  ds_read_b64_tr_b16 v[58:59], v23 offset:52736
  s_waitcnt lgkmcnt(7)
  v_mfma_f32_32x32x16_bf16 v[128:143], v[36:39], v[28:31], v[128:143]
  v_mfma_f32_32x32x16_bf16 v[144:159], v[28:31], v[40:43], v[144:159]
  v_mfma_f32_32x32x16_bf16 v[176:191], v[28:31], v[44:47], v[176:191]
  s_waitcnt lgkmcnt(0)
  v_mfma_f32_32x32x16_bf16 v[128:143], v[48:51], v[32:35], v[128:143]
  v_mfma_f32_32x32x16_bf16 v[144:159], v[32:35], v[52:55], v[144:159]
  v_mfma_f32_32x32x16_bf16 v[176:191], v[32:35], v[56:59], v[176:191]
  s_barrier
  ds_read_b128 v[28:31], v10 offset:0
  ds_read_b64_tr_b16 v[36:37], v18 offset:0
  ds_read_b64_tr_b16 v[38:39], v18 offset:1536
  ds_read_b64_tr_b16 v[40:41], v19 offset:0
  ds_read_b64_tr_b16 v[42:43], v19 offset:1536
  ds_read_b64_tr_b16 v[44:45], v20 offset:0
  ds_read_b64_tr_b16 v[46:47], v20 offset:1536
  ds_read_b128 v[32:35], v11 offset:0
  ds_read_b64_tr_b16 v[48:49], v18 offset:6144
  ds_read_b64_tr_b16 v[50:51], v18 offset:7680
  ds_read_b64_tr_b16 v[52:53], v19 offset:6144
  ds_read_b64_tr_b16 v[54:55], v19 offset:7680
  ds_read_b64_tr_b16 v[56:57], v20 offset:6144
  ds_read_b64_tr_b16 v[58:59], v20 offset:7680
  s_waitcnt lgkmcnt(7)
  v_mfma_f32_32x32x16_bf16 v[128:143], v[36:39], v[28:31], v[128:143]
  v_mfma_f32_32x32x16_bf16 v[144:159], v[28:31], v[40:43], v[144:159]
  v_mfma_f32_32x32x16_bf16 v[176:191], v[28:31], v[44:47], v[176:191]
  ds_read_b128 v[28:31], v12 offset:0
  ds_read_b64_tr_b16 v[36:37], v18 offset:12288
  ds_read_b64_tr_b16 v[38:39], v18 offset:13824
  ds_read_b64_tr_b16 v[40:41], v19 offset:12288
  ds_read_b64_tr_b16 v[42:43], v19 offset:13824
  ds_read_b64_tr_b16 v[44:45], v20 offset:12288
  ds_read_b64_tr_b16 v[46:47], v20 offset:13824
  s_waitcnt lgkmcnt(7)
  v_mfma_f32_32x32x16_bf16 v[128:143], v[48:51], v[32:35], v[128:143]
  v_mfma_f32_32x32x16_bf16 v[144:159], v[32:35], v[52:55], v[144:159]
  v_mfma_f32_32x32x16_bf16 v[176:191], v[32:35], v[56:59], v[176:191]
  ds_read_b128 v[32:35], v13 offset:0
  ds_read_b64_tr_b16 v[48:49], v18 offset:18432
  ds_read_b64_tr_b16 v[50:51], v18 offset:19968
  ds_read_b64_tr_b16 v[52:53], v19 offset:18432
  ds_read_b64_tr_b16 v[54:55], v19 offset:19968
  ds_read_b64_tr_b16 v[56:57], v20 offset:18432
  ds_read_b64_tr_b16 v[58:59], v20 offset:19968
  s_waitcnt lgkmcnt(7)
  v_mfma_f32_32x32x16_bf16 v[128:143], v[36:39], v[28:31], v[128:143]
  v_mfma_f32_32x32x16_bf16 v[144:159], v[28:31], v[40:43], v[144:159]
  v_mfma_f32_32x32x16_bf16 v[176:191], v[28:31], v[44:47], v[176:191]
  s_waitcnt lgkmcnt(0)
  v_mfma_f32_32x32x16_bf16 v[128:143], v[48:51], v[32:35], v[128:143]
  v_mfma_f32_32x32x16_bf16 v[144:159], v[32:35], v[52:55], v[144:159]
  v_mfma_f32_32x32x16_bf16 v[176:191], v[32:35], v[56:59], v[176:191]
  s_barrier
  ds_read_b128 v[28:31], v10 offset:32768
  ds_read_b64_tr_b16 v[36:37], v18 offset:32768
  ds_read_b64_tr_b16 v[38:39], v18 offset:34304
  ds_read_b64_tr_b16 v[40:41], v19 offset:32768
  ds_read_b64_tr_b16 v[42:43], v19 offset:34304
  ds_read_b64_tr_b16 v[44:45], v20 offset:32768
  ds_read_b64_tr_b16 v[46:47], v20 offset:34304
  ds_read_b128 v[32:35], v11 offset:32768
  ds_read_b64_tr_b16 v[48:49], v18 offset:38912
  ds_read_b64_tr_b16 v[50:51], v18 offset:40448
  ds_read_b64_tr_b16 v[52:53], v19 offset:38912
  ds_read_b64_tr_b16 v[54:55], v19 offset:40448
  ds_read_b64_tr_b16 v[56:57], v20 offset:38912
  ds_read_b64_tr_b16 v[58:59], v20 offset:40448
  s_waitcnt lgkmcnt(7)
  v_mfma_f32_32x32x16_bf16 v[128:143], v[36:39], v[28:31], v[128:143]
  v_mfma_f32_32x32x16_bf16 v[144:159], v[28:31], v[40:43], v[144:159]
  v_mfma_f32_32x32x16_bf16 v[176:191], v[28:31], v[44:47], v[176:191]
  ds_read_b128 v[28:31], v12 offset:32768
  ds_read_b64_tr_b16 v[36:37], v18 offset:45056
  ds_read_b64_tr_b16 v[38:39], v18 offset:46592
  ds_read_b64_tr_b16 v[40:41], v19 offset:45056
  ds_read_b64_tr_b16 v[42:43], v19 offset:46592
  ds_read_b64_tr_b16 v[44:45], v20 offset:45056
  ds_read_b64_tr_b16 v[46:47], v20 offset:46592
  s_waitcnt lgkmcnt(7)
  v_mfma_f32_32x32x16_bf16 v[128:143], v[48:51], v[32:35], v[128:143]
  v_mfma_f32_32x32x16_bf16 v[144:159], v[32:35], v[52:55], v[144:159]
  v_mfma_f32_32x32x16_bf16 v[176:191], v[32:35], v[56:59], v[176:191]
  ds_read_b128 v[32:35], v13 offset:32768
  ds_read_b64_tr_b16 v[48:49], v18 offset:51200
  ds_read_b64_tr_b16 v[50:51], v18 offset:52736
  ds_read_b64_tr_b16 v[52:53], v19 offset:51200
  ds_read_b64_tr_b16 v[54:55], v19 offset:52736
  ds_read_b64_tr_b16 v[56:57], v20 offset:51200
  ds_read_b64_tr_b16 v[58:59], v20 offset:52736
  s_waitcnt lgkmcnt(7)
  v_mfma_f32_32x32x16_bf16 v[128:143], v[36:39], v[28:31], v[128:143]
  v_mfma_f32_32x32x16_bf16 v[144:159], v[28:31], v[40:43], v[144:159]
  v_mfma_f32_32x32x16_bf16 v[176:191], v[28:31], v[44:47], v[176:191]
  s_waitcnt lgkmcnt(0)
  v_mfma_f32_32x32x16_bf16 v[128:143], v[48:51], v[32:35], v[128:143]
  v_mfma_f32_32x32x16_bf16 v[144:159], v[32:35], v[52:55], v[144:159]
  v_mfma_f32_32x32x16_bf16 v[176:191], v[32:35], v[56:59], v[176:191]
  s_barrier
  ds_read_b128 v[28:31], v14 offset:0
  ds_read_b64_tr_b16 v[36:37], v21 offset:0
  ds_read_b64_tr_b16 v[38:39], v21 offset:1536
  ds_read_b64_tr_b16 v[40:41], v22 offset:0
  ds_read_b64_tr_b16 v[42:43], v22 offset:1536
  ds_read_b64_tr_b16 v[44:45], v23 offset:0
  ds_read_b64_tr_b16 v[46:47], v23 offset:1536
  ds_read_b128 v[32:35], v15 offset:0
  ds_read_b64_tr_b16 v[48:49], v21 offset:6144
  ds_read_b64_tr_b16 v[50:51], v21 offset:7680
  ds_read_b64_tr_b16 v[52:53], v22 offset:6144
  ds_read_b64_tr_b16 v[54:55], v22 offset:7680
  ds_read_b64_tr_b16 v[56:57], v23 offset:6144
  ds_read_b64_tr_b16 v[58:59], v23 offset:7680
  s_waitcnt lgkmcnt(7)
  v_mfma_f32_32x32x16_bf16 v[128:143], v[36:39], v[28:31], v[128:143]
  v_mfma_f32_32x32x16_bf16 v[144:159], v[28:31], v[40:43], v[144:159]
  v_mfma_f32_32x32x16_bf16 v[176:191], v[28:31], v[44:47], v[176:191]
  ds_read_b128 v[28:31], v16 offset:0
  ds_read_b64_tr_b16 v[36:37], v21 offset:12288
  ds_read_b64_tr_b16 v[38:39], v21 offset:13824
  ds_read_b64_tr_b16 v[40:41], v22 offset:12288
  ds_read_b64_tr_b16 v[42:43], v22 offset:13824
  ds_read_b64_tr_b16 v[44:45], v23 offset:12288
  ds_read_b64_tr_b16 v[46:47], v23 offset:13824
  s_waitcnt lgkmcnt(7)
  v_mfma_f32_32x32x16_bf16 v[128:143], v[48:51], v[32:35], v[128:143]
  v_mfma_f32_32x32x16_bf16 v[144:159], v[32:35], v[52:55], v[144:159]
  v_mfma_f32_32x32x16_bf16 v[176:191], v[32:35], v[56:59], v[176:191]
  ds_read_b128 v[32:35], v17 offset:0
  ds_read_b64_tr_b16 v[48:49], v21 offset:18432
  ds_read_b64_tr_b16 v[50:51], v21 offset:19968
  ds_read_b64_tr_b16 v[52:53], v22 offset:18432
  ds_read_b64_tr_b16 v[54:55], v22 offset:19968
  ds_read_b64_tr_b16 v[56:57], v23 offset:18432
  ds_read_b64_tr_b16 v[58:59], v23 offset:19968
  s_waitcnt lgkmcnt(7)
  v_mfma_f32_32x32x16_bf16 v[128:143], v[36:39], v[28:31], v[128:143]
  v_mfma_f32_32x32x16_bf16 v[144:159], v[28:31], v[40:43], v[144:159]
  v_mfma_f32_32x32x16_bf16 v[176:191], v[28:31], v[44:47], v[176:191]
  s_waitcnt lgkmcnt(0)
  v_mfma_f32_32x32x16_bf16 v[128:143], v[48:51], v[32:35], v[128:143]
  v_mfma_f32_32x32x16_bf16 v[144:159], v[32:35], v[52:55], v[144:159]
  v_mfma_f32_32x32x16_bf16 v[176:191], v[32:35], v[56:59], v[176:191]
  s_barrier
  ds_read_b128 v[28:31], v14 offset:32768
  ds_read_b64_tr_b16 v[36:37], v21 offset:32768
  ds_read_b64_tr_b16 v[38:39], v21 offset:34304
  ds_read_b64_tr_b16 v[40:41], v22 offset:32768
  ds_read_b64_tr_b16 v[42:43], v22 offset:34304
  ds_read_b64_tr_b16 v[44:45], v23 offset:32768
  ds_read_b64_tr_b16 v[46:47], v23 offset:34304
  ds_read_b128 v[32:35], v15 offset:32768
  ds_read_b64_tr_b16 v[48:49], v21 offset:38912
  ds_read_b64_tr_b16 v[50:51], v21 offset:40448
  ds_read_b64_tr_b16 v[52:53], v22 offset:38912
  ds_read_b64_tr_b16 v[54:55], v22 offset:40448
  ds_read_b64_tr_b16 v[56:57], v23 offset:38912
  ds_read_b64_tr_b16 v[58:59], v23 offset:40448
  s_waitcnt lgkmcnt(7)
  v_mfma_f32_32x32x16_bf16 v[128:143], v[36:39], v[28:31], v[128:143]
  v_mfma_f32_32x32x16_bf16 v[144:159], v[28:31], v[40:43], v[144:159]
  v_mfma_f32_32x32x16_bf16 v[176:191], v[28:31], v[44:47], v[176:191]
  ds_read_b128 v[28:31], v16 offset:32768
  ds_read_b64_tr_b16 v[36:37], v21 offset:45056
  ds_read_b64_tr_b16 v[38:39], v21 offset:46592
  ds_read_b64_tr_b16 v[40:41], v22 offset:45056
  ds_read_b64_tr_b16 v[42:43], v22 offset:46592
  ds_read_b64_tr_b16 v[44:45], v23 offset:45056
  ds_read_b64_tr_b16 v[46:47], v23 offset:46592
  s_waitcnt lgkmcnt(7)
  v_mfma_f32_32x32x16_bf16 v[128:143], v[48:51], v[32:35], v[128:143]
  v_mfma_f32_32x32x16_bf16 v[144:159], v[32:35], v[52:55], v[144:159]
  v_mfma_f32_32x32x16_bf16 v[176:191], v[32:35], v[56:59], v[176:191]
  ds_read_b128 v[32:35], v17 offset:32768
  ds_read_b64_tr_b16 v[48:49], v21 offset:51200
  ds_read_b64_tr_b16 v[50:51], v21 offset:52736
  ds_read_b64_tr_b16 v[52:53], v22 offset:51200
  ds_read_b64_tr_b16 v[54:55], v22 offset:52736
  ds_read_b64_tr_b16 v[56:57], v23 offset:51200
  ds_read_b64_tr_b16 v[58:59], v23 offset:52736
  s_waitcnt lgkmcnt(7)
  v_mfma_f32_32x32x16_bf16 v[128:143], v[36:39], v[28:31], v[128:143]
  v_mfma_f32_32x32x16_bf16 v[144:159], v[28:31], v[40:43], v[144:159]
  v_mfma_f32_32x32x16_bf16 v[176:191], v[28:31], v[44:47], v[176:191]
  s_waitcnt lgkmcnt(0)
  v_mfma_f32_32x32x16_bf16 v[128:143], v[48:51], v[32:35], v[128:143]
  v_mfma_f32_32x32x16_bf16 v[144:159], v[32:35], v[52:55], v[144:159]
  v_mfma_f32_32x32x16_bf16 v[176:191], v[32:35], v[56:59], v[176:191]
  s_nop 15
  v_cvt_pk_bf16_f32 v112, v128, v129
  v_cvt_pk_bf16_f32 v113, v130, v131
  v_cvt_pk_bf16_f32 v114, v132, v133
  v_cvt_pk_bf16_f32 v115, v134, v135
  s_add_u32 s59, s52, 6684672
  s_add_u32 s59, s59, s54
  buffer_store_dwordx4 v[112:115], v24, s[4:7], s59 offen sc1
  v_cvt_pk_bf16_f32 v116, v136, v137
  v_cvt_pk_bf16_f32 v117, v138, v139
  v_cvt_pk_bf16_f32 v118, v140, v141
  v_cvt_pk_bf16_f32 v119, v142, v143
  s_add_u32 s59, s52, 6881280
  s_add_u32 s59, s59, s54
  buffer_store_dwordx4 v[116:119], v24, s[4:7], s59 offen sc1
  v_cvt_pk_bf16_f32 v120, v144, v145
  v_cvt_pk_bf16_f32 v121, v146, v147
  v_cvt_pk_bf16_f32 v122, v148, v149
  v_cvt_pk_bf16_f32 v123, v150, v151
  s_add_u32 s59, s52, 6292480
  s_add_u32 s59, s59, s54
  buffer_store_dwordx4 v[120:123], v25, s[4:7], s59 offen sc1
  v_cvt_pk_bf16_f32 v124, v152, v153
  v_cvt_pk_bf16_f32 v125, v154, v155
  v_cvt_pk_bf16_f32 v126, v156, v157
  v_cvt_pk_bf16_f32 v127, v158, v159
  s_add_u32 s59, s52, 6292992
  s_add_u32 s59, s59, s54
  buffer_store_dwordx4 v[124:127], v25, s[4:7], s59 offen sc1
  v_cvt_pk_bf16_f32 v112, v176, v177
  v_cvt_pk_bf16_f32 v113, v178, v179
  v_cvt_pk_bf16_f32 v114, v180, v181
  v_cvt_pk_bf16_f32 v115, v182, v183
  s_add_u32 s59, s52, 6685696
  s_add_u32 s59, s59, s54
  buffer_store_dwordx4 v[112:115], v25, s[4:7], s59 offen sc1
  v_cvt_pk_bf16_f32 v116, v184, v185
  v_cvt_pk_bf16_f32 v117, v186, v187
  v_cvt_pk_bf16_f32 v118, v188, v189
  v_cvt_pk_bf16_f32 v119, v190, v191
  s_add_u32 s59, s52, 6686208
  s_add_u32 s59, s59, s54
  buffer_store_dwordx4 v[116:119], v25, s[4:7], s59 offen sc1
  s_branch Lfa_attn
Lfa_attn:
  s_and_b32 s64, s3, 3
  s_lshl_b32 s64, s64, 11
  s_add_u32 s64, s64, 32768
  v_add_u32 v250, s64, v247
  v_add_u32 v251, 131072, v247
  s_mul_i32 s62, s30, 196608
  s_lshl_b32 s63, s3, 10
  s_add_u32 s62, s62, s63
  v_lshrrev_b32 v0, 3, v1
  v_lshlrev_b32 v0, 10, v0
  v_bfe_u32 v252, v1, 4, 1
  v_lshlrev_b32 v252, 2, v252
  v_and_b32 v253, 7, v1
  v_xor_b32 v252, v252, v253
  v_lshlrev_b32 v252, 4, v252
  v_add_u32 v0, v0, v252
  s_lshl_b32 s34, s31, 3
  s_add_u32 s34, s34, s3
  s_min_u32 s35, s34, 8
  s_mul_i32 s36, s30, 196608
  s_add_u32 s36, s36, 6291456
  s_load_dwordx2 s[44:45], s[0:1], 16
  s_load_dwordx4 s[48:51], s[0:1], 40
  s_bfe_u32 s75, s2, 0x20001
  s_and_b32 s52, s2, 1
  s_lshl_b32 s52, s52, 2
  s_bfe_u32 s53, s2, 0x20003
  s_add_u32 s39, s52, s53
  s_lshl_b32 s42, s3, 13
  s_lshl_b32 s52, s39, 7
  s_add_u32 s42, s42, s52
  s_waitcnt lgkmcnt(0)
  s_mov_b32 s8, s44
  s_and_b32 s9, s45, 0xffff
  s_mov_b32 s10, 524288
  s_mov_b32 s11, 0x00020000
  s_mov_b32 s12, s48
  s_and_b32 s13, s49, 0xffff
  s_mov_b32 s14, 524288
  s_mov_b32 s15, 0x00020000
  s_mov_b32 s16, s50
  s_and_b32 s17, s51, 0xffff
  s_mov_b32 s18, 4194304
  s_mov_b32 s19, 0x00020000
  s_waitcnt vmcnt(8)
  s_barrier
  ds_read_b128 v[4:7], v250
  ds_read_b128 v[8:11], v250 offset:1024
  ds_read_b128 v[176:179], v251
  s_waitcnt lgkmcnt(0)
  v_mfma_f32_32x32x16_bf16 v[80:95], v[176:179], v[4:7], 0
  v_mfma_f32_32x32x16_bf16 v[112:127], v[176:179], v[8:11], 0
  s_cmp_eq_u32 s3, 4
  s_cbranch_scc0 La_nnw
  v_mov_b32 v250, 98816
  v_mov_b32 v251, s28
  ds_write_b32 v250, v251
  s_waitcnt lgkmcnt(0)
La_nnw:
  v_mov_b32 v16, 0
  v_mov_b32 v17, 0
  v_mov_b32 v18, 0
  v_mov_b32 v19, 0
  v_mov_b32 v20, 0
  v_mov_b32 v21, 0
  v_mov_b32 v32, 0
  v_mov_b32 v33, 0
  v_mov_b32 v34, 0
  v_mov_b32 v35, 0
  v_mov_b32 v36, 0
  v_mov_b32 v37, 0
  v_max_f32 v248, v80, v81
  v_max3_f32 v248, v82, v83, v248
  v_max3_f32 v248, v84, v85, v248
  v_max3_f32 v248, v86, v87, v248
  v_max3_f32 v248, v88, v89, v248
  v_max3_f32 v248, v90, v91, v248
  v_max3_f32 v248, v92, v93, v248
  v_max3_f32 v248, v94, v95, v248
  v_max_f32 v249, v112, v113
  v_max3_f32 v249, v114, v115, v249
  v_max3_f32 v249, v116, v117, v249
  v_max3_f32 v249, v118, v119, v249
  v_max3_f32 v249, v120, v121, v249
  v_max3_f32 v249, v122, v123, v249
  v_max3_f32 v249, v124, v125, v249
  v_max3_f32 v249, v126, v127, v249
La_main:
  ds_read_b128 v[176:179], v244
  s_mov_b64 exec, s[40:41]
  ds_read_b128 v[160:163], v245 offset:0
  ds_read_b128 v[164:167], v245 offset:512
  s_mov_b64 exec, -1
  ds_read_b128 v[180:183], v244 offset:2048
  v_mov_b32 v246, v248
  s_nop 1
  v_permlane32_swap_b32 v248, v246
  s_nop 1
  v_max_f32 v248, v248, v246
  v_mov_b32 v246, v249
  s_nop 1
  v_permlane32_swap_b32 v249, v246
  s_nop 1
  v_max_f32 v249, v249, v246
  v_sub_f32 v48, 0, v248
  v_sub_f32 v49, 0, v248
  v_sub_f32 v50, 0, v248
  v_sub_f32 v51, 0, v248
  v_sub_f32 v52, 0, v248
  v_sub_f32 v53, 0, v248
  v_sub_f32 v54, 0, v248
  v_sub_f32 v55, 0, v248
  v_sub_f32 v56, 0, v248
  v_sub_f32 v57, 0, v248
  v_sub_f32 v58, 0, v248
  v_sub_f32 v59, 0, v248
  v_sub_f32 v60, 0, v248
  v_sub_f32 v61, 0, v248
  v_sub_f32 v62, 0, v248
  v_sub_f32 v63, 0, v248
  v_sub_f32 v64, 0, v249
  v_sub_f32 v65, 0, v249
  v_sub_f32 v66, 0, v249
  v_sub_f32 v67, 0, v249
  v_sub_f32 v68, 0, v249
  v_sub_f32 v69, 0, v249
  v_sub_f32 v70, 0, v249
  v_sub_f32 v71, 0, v249
  v_sub_f32 v72, 0, v249
  v_sub_f32 v73, 0, v249
  v_sub_f32 v74, 0, v249
  v_sub_f32 v75, 0, v249
  v_sub_f32 v76, 0, v249
  v_sub_f32 v77, 0, v249
  v_sub_f32 v78, 0, v249
  v_sub_f32 v79, 0, v249
  s_waitcnt lgkmcnt(3)
  v_mfma_f32_32x32x16_bf16 v[80:95], v[176:179], v[4:7], v[48:63]
  v_mfma_f32_32x32x16_bf16 v[112:127], v[176:179], v[8:11], v[64:79]
  s_cmp_lg_u32 s73, 0
  s_cbranch_scc1 La_rolled
  v_add_u32 v184, 0x10000, v254
  v_add_u32 v185, 0x10000, v255
  s_nop 7
.p2align 6
  v_exp_f32 v80, v80
  v_exp_f32 v81, v81
  v_exp_f32 v82, v82
  v_exp_f32 v83, v83
  v_exp_f32 v84, v84
  v_cvt_pk_bf16_f32 v144, v80, v81
  v_exp_f32 v85, v85
  v_cvt_pk_bf16_f32 v145, v82, v83
  s_waitcnt lgkmcnt(0)
  v_mfma_f32_32x32x16_bf16 v[96:111], v[180:183], v[4:7], v[48:63]
  v_exp_f32 v86, v86
  v_exp_f32 v87, v87
  v_exp_f32 v88, v88
  v_cvt_pk_bf16_f32 v146, v84, v85
  v_exp_f32 v89, v89
  v_cvt_pk_bf16_f32 v147, v86, v87
  v_exp_f32 v90, v90
  v_exp_f32 v91, v91
  v_mfma_f32_32x32x16_bf16 v[16:31], v[160:163], v[144:147], 0
  v_exp_f32 v92, v92
  v_cvt_pk_bf16_f32 v148, v88, v89
  v_exp_f32 v93, v93
  v_cvt_pk_bf16_f32 v149, v90, v91
  v_exp_f32 v94, v94
  v_exp_f32 v95, v95
  s_mov_b64 exec, s[40:41]
  ds_read_b128 v[168:171], v245 offset:2048
  ds_read_b128 v[172:175], v245 offset:2560
  s_mov_b64 exec, -1
  v_cvt_pk_bf16_f32 v150, v92, v93
  v_cvt_pk_bf16_f32 v151, v94, v95
  v_exp_f32 v112, v112
  v_exp_f32 v113, v113
  v_mfma_f32_32x32x16_bf16 v[16:31], v[164:167], v[148:151], v[16:31]
  v_exp_f32 v114, v114
  v_exp_f32 v115, v115
  v_exp_f32 v116, v116
  v_cvt_pk_bf16_f32 v152, v112, v113
  v_exp_f32 v117, v117
  v_cvt_pk_bf16_f32 v153, v114, v115
  v_mfma_f32_32x32x16_bf16 v[128:143], v[180:183], v[8:11], v[64:79]
  ds_read_b128 v[176:179], v244 offset:4096
  v_exp_f32 v118, v118
  v_exp_f32 v119, v119
  v_exp_f32 v120, v120
  v_cvt_pk_bf16_f32 v154, v116, v117
  v_exp_f32 v121, v121
  v_cvt_pk_bf16_f32 v155, v118, v119
  v_exp_f32 v122, v122
  v_exp_f32 v123, v123
  v_mfma_f32_32x32x16_bf16 v[32:47], v[160:163], v[152:155], 0
  v_exp_f32 v124, v124
  v_cvt_pk_bf16_f32 v156, v120, v121
  v_exp_f32 v125, v125
  v_cvt_pk_bf16_f32 v157, v122, v123
  v_exp_f32 v126, v126
  v_exp_f32 v127, v127
  v_cvt_pk_bf16_f32 v158, v124, v125
  v_cvt_pk_bf16_f32 v159, v126, v127
  v_exp_f32 v96, v96
  v_exp_f32 v97, v97
  v_mfma_f32_32x32x16_bf16 v[32:47], v[164:167], v[156:159], v[32:47]
  v_exp_f32 v98, v98
  v_exp_f32 v99, v99
  v_exp_f32 v100, v100
  v_cvt_pk_bf16_f32 v144, v96, v97
  v_exp_f32 v101, v101
  v_cvt_pk_bf16_f32 v145, v98, v99
  s_waitcnt lgkmcnt(0)
  v_mfma_f32_32x32x16_bf16 v[80:95], v[176:179], v[4:7], v[48:63]
  v_exp_f32 v102, v102
  v_exp_f32 v103, v103
  v_exp_f32 v104, v104
  v_cvt_pk_bf16_f32 v146, v100, v101
  v_exp_f32 v105, v105
  v_cvt_pk_bf16_f32 v147, v102, v103
  v_exp_f32 v106, v106
  v_exp_f32 v107, v107
  v_mfma_f32_32x32x16_bf16 v[16:31], v[168:171], v[144:147], v[16:31]
  v_exp_f32 v108, v108
  v_cvt_pk_bf16_f32 v148, v104, v105
  v_exp_f32 v109, v109
  v_cvt_pk_bf16_f32 v149, v106, v107
  v_exp_f32 v110, v110
  v_exp_f32 v111, v111
  s_mov_b64 exec, s[40:41]
  ds_read_b128 v[160:163], v245 offset:4096
  ds_read_b128 v[164:167], v245 offset:4608
  s_mov_b64 exec, -1
  v_cvt_pk_bf16_f32 v150, v108, v109
  v_cvt_pk_bf16_f32 v151, v110, v111
  v_exp_f32 v128, v128
  v_exp_f32 v129, v129
  v_mfma_f32_32x32x16_bf16 v[16:31], v[172:175], v[148:151], v[16:31]
  v_exp_f32 v130, v130
  v_exp_f32 v131, v131
  v_exp_f32 v132, v132
  v_cvt_pk_bf16_f32 v152, v128, v129
  v_exp_f32 v133, v133
  v_cvt_pk_bf16_f32 v153, v130, v131
  v_mfma_f32_32x32x16_bf16 v[112:127], v[176:179], v[8:11], v[64:79]
  ds_read_b128 v[180:183], v244 offset:6144
  v_exp_f32 v134, v134
  v_exp_f32 v135, v135
  v_exp_f32 v136, v136
  v_cvt_pk_bf16_f32 v154, v132, v133
  v_exp_f32 v137, v137
  v_cvt_pk_bf16_f32 v155, v134, v135
  v_exp_f32 v138, v138
  v_exp_f32 v139, v139
  v_mfma_f32_32x32x16_bf16 v[32:47], v[168:171], v[152:155], v[32:47]
  v_exp_f32 v140, v140
  v_cvt_pk_bf16_f32 v156, v136, v137
  v_exp_f32 v141, v141
  v_cvt_pk_bf16_f32 v157, v138, v139
  v_exp_f32 v142, v142
  v_exp_f32 v143, v143
  v_cvt_pk_bf16_f32 v158, v140, v141
  v_cvt_pk_bf16_f32 v159, v142, v143
  v_exp_f32 v80, v80
  v_exp_f32 v81, v81
  v_mfma_f32_32x32x16_bf16 v[32:47], v[172:175], v[156:159], v[32:47]
  v_exp_f32 v82, v82
  v_exp_f32 v83, v83
  v_exp_f32 v84, v84
  v_cvt_pk_bf16_f32 v144, v80, v81
  v_exp_f32 v85, v85
  v_cvt_pk_bf16_f32 v145, v82, v83
  s_waitcnt lgkmcnt(0)
  v_mfma_f32_32x32x16_bf16 v[96:111], v[180:183], v[4:7], v[48:63]
  v_exp_f32 v86, v86
  v_exp_f32 v87, v87
  v_exp_f32 v88, v88
  v_cvt_pk_bf16_f32 v146, v84, v85
  v_exp_f32 v89, v89
  v_cvt_pk_bf16_f32 v147, v86, v87
  v_exp_f32 v90, v90
  v_exp_f32 v91, v91
  v_mfma_f32_32x32x16_bf16 v[16:31], v[160:163], v[144:147], v[16:31]
  v_exp_f32 v92, v92
  v_cvt_pk_bf16_f32 v148, v88, v89
  v_exp_f32 v93, v93
  v_cvt_pk_bf16_f32 v149, v90, v91
  v_exp_f32 v94, v94
  v_exp_f32 v95, v95
  s_mov_b64 exec, s[40:41]
  ds_read_b128 v[168:171], v245 offset:6144
  ds_read_b128 v[172:175], v245 offset:6656
  s_mov_b64 exec, -1
  v_cvt_pk_bf16_f32 v150, v92, v93
  v_cvt_pk_bf16_f32 v151, v94, v95
  v_exp_f32 v112, v112
  v_exp_f32 v113, v113
  v_mfma_f32_32x32x16_bf16 v[16:31], v[164:167], v[148:151], v[16:31]
  v_exp_f32 v114, v114
  v_exp_f32 v115, v115
  v_exp_f32 v116, v116
  v_cvt_pk_bf16_f32 v152, v112, v113
  v_exp_f32 v117, v117
  v_cvt_pk_bf16_f32 v153, v114, v115
  v_mfma_f32_32x32x16_bf16 v[128:143], v[180:183], v[8:11], v[64:79]
  ds_read_b128 v[176:179], v244 offset:8192
  v_exp_f32 v118, v118
  v_exp_f32 v119, v119
  v_exp_f32 v120, v120
  v_cvt_pk_bf16_f32 v154, v116, v117
  v_exp_f32 v121, v121
  v_cvt_pk_bf16_f32 v155, v118, v119
  v_exp_f32 v122, v122
  v_exp_f32 v123, v123
  v_mfma_f32_32x32x16_bf16 v[32:47], v[160:163], v[152:155], v[32:47]
  v_exp_f32 v124, v124
  v_cvt_pk_bf16_f32 v156, v120, v121
  v_exp_f32 v125, v125
  v_cvt_pk_bf16_f32 v157, v122, v123
  v_exp_f32 v126, v126
  v_exp_f32 v127, v127
  v_cvt_pk_bf16_f32 v158, v124, v125
  v_cvt_pk_bf16_f32 v159, v126, v127
  v_exp_f32 v96, v96
  v_exp_f32 v97, v97
  v_mfma_f32_32x32x16_bf16 v[32:47], v[164:167], v[156:159], v[32:47]
  v_exp_f32 v98, v98
  v_exp_f32 v99, v99
  v_exp_f32 v100, v100
  v_cvt_pk_bf16_f32 v144, v96, v97
  v_exp_f32 v101, v101
  v_cvt_pk_bf16_f32 v145, v98, v99
  s_waitcnt lgkmcnt(0)
  v_mfma_f32_32x32x16_bf16 v[80:95], v[176:179], v[4:7], v[48:63]
  v_exp_f32 v102, v102
  v_exp_f32 v103, v103
  v_exp_f32 v104, v104
  v_cvt_pk_bf16_f32 v146, v100, v101
  v_exp_f32 v105, v105
  v_cvt_pk_bf16_f32 v147, v102, v103
  v_exp_f32 v106, v106
  v_exp_f32 v107, v107
  v_mfma_f32_32x32x16_bf16 v[16:31], v[168:171], v[144:147], v[16:31]
  v_exp_f32 v108, v108
  v_cvt_pk_bf16_f32 v148, v104, v105
  v_exp_f32 v109, v109
  v_cvt_pk_bf16_f32 v149, v106, v107
  v_exp_f32 v110, v110
  v_exp_f32 v111, v111
  s_mov_b64 exec, s[40:41]
  ds_read_b128 v[160:163], v245 offset:8192
  ds_read_b128 v[164:167], v245 offset:8704
  s_mov_b64 exec, -1
  v_cvt_pk_bf16_f32 v150, v108, v109
  v_cvt_pk_bf16_f32 v151, v110, v111
  v_exp_f32 v128, v128
  v_exp_f32 v129, v129
  v_mfma_f32_32x32x16_bf16 v[16:31], v[172:175], v[148:151], v[16:31]
  v_exp_f32 v130, v130
  v_exp_f32 v131, v131
  v_exp_f32 v132, v132
  v_cvt_pk_bf16_f32 v152, v128, v129
  v_exp_f32 v133, v133
  v_cvt_pk_bf16_f32 v153, v130, v131
  v_mfma_f32_32x32x16_bf16 v[112:127], v[176:179], v[8:11], v[64:79]
  ds_read_b128 v[180:183], v244 offset:10240
  v_exp_f32 v134, v134
  v_exp_f32 v135, v135
  v_exp_f32 v136, v136
  v_cvt_pk_bf16_f32 v154, v132, v133
  v_exp_f32 v137, v137
  v_cvt_pk_bf16_f32 v155, v134, v135
  v_exp_f32 v138, v138
  v_exp_f32 v139, v139
  v_mfma_f32_32x32x16_bf16 v[32:47], v[168:171], v[152:155], v[32:47]
  v_exp_f32 v140, v140
  v_cvt_pk_bf16_f32 v156, v136, v137
  v_exp_f32 v141, v141
  v_cvt_pk_bf16_f32 v157, v138, v139
  v_exp_f32 v142, v142
  v_exp_f32 v143, v143
  v_cvt_pk_bf16_f32 v158, v140, v141
  v_cvt_pk_bf16_f32 v159, v142, v143
  v_exp_f32 v80, v80
  v_exp_f32 v81, v81
  v_mfma_f32_32x32x16_bf16 v[32:47], v[172:175], v[156:159], v[32:47]
  v_exp_f32 v82, v82
  v_exp_f32 v83, v83
  v_exp_f32 v84, v84
  v_cvt_pk_bf16_f32 v144, v80, v81
  v_exp_f32 v85, v85
  v_cvt_pk_bf16_f32 v145, v82, v83
  s_waitcnt lgkmcnt(0)
  v_mfma_f32_32x32x16_bf16 v[96:111], v[180:183], v[4:7], v[48:63]
  v_exp_f32 v86, v86
  v_exp_f32 v87, v87
  v_exp_f32 v88, v88
  v_cvt_pk_bf16_f32 v146, v84, v85
  v_exp_f32 v89, v89
  v_cvt_pk_bf16_f32 v147, v86, v87
  v_exp_f32 v90, v90
  v_exp_f32 v91, v91
  v_mfma_f32_32x32x16_bf16 v[16:31], v[160:163], v[144:147], v[16:31]
  v_exp_f32 v92, v92
  v_cvt_pk_bf16_f32 v148, v88, v89
  v_exp_f32 v93, v93
  v_cvt_pk_bf16_f32 v149, v90, v91
  v_exp_f32 v94, v94
  v_exp_f32 v95, v95
  s_mov_b64 exec, s[40:41]
  ds_read_b128 v[168:171], v245 offset:10240
  ds_read_b128 v[172:175], v245 offset:10752
  s_mov_b64 exec, -1
  v_cvt_pk_bf16_f32 v150, v92, v93
  v_cvt_pk_bf16_f32 v151, v94, v95
  v_exp_f32 v112, v112
  v_exp_f32 v113, v113
  v_mfma_f32_32x32x16_bf16 v[16:31], v[164:167], v[148:151], v[16:31]
  v_exp_f32 v114, v114
  v_exp_f32 v115, v115
  v_exp_f32 v116, v116
  v_cvt_pk_bf16_f32 v152, v112, v113
  v_exp_f32 v117, v117
  v_cvt_pk_bf16_f32 v153, v114, v115
  v_mfma_f32_32x32x16_bf16 v[128:143], v[180:183], v[8:11], v[64:79]
  ds_read_b128 v[176:179], v244 offset:12288
  v_exp_f32 v118, v118
  v_exp_f32 v119, v119
  v_exp_f32 v120, v120
  v_cvt_pk_bf16_f32 v154, v116, v117
  v_exp_f32 v121, v121
  v_cvt_pk_bf16_f32 v155, v118, v119
  v_exp_f32 v122, v122
  v_exp_f32 v123, v123
  v_mfma_f32_32x32x16_bf16 v[32:47], v[160:163], v[152:155], v[32:47]
  v_exp_f32 v124, v124
  v_cvt_pk_bf16_f32 v156, v120, v121
  v_exp_f32 v125, v125
  v_cvt_pk_bf16_f32 v157, v122, v123
  v_exp_f32 v126, v126
  v_exp_f32 v127, v127
  v_cvt_pk_bf16_f32 v158, v124, v125
  v_cvt_pk_bf16_f32 v159, v126, v127
  s_waitcnt vmcnt(0)
  s_barrier
  s_add_u32 m0, s63, 32768
  s_add_u32 s66, s62, 98304
  buffer_load_dwordx4 v247, s[4:7], s66 offen sc1 lds
  s_add_u32 m0, s63, 40960
  s_add_u32 s66, s62, 106496
  buffer_load_dwordx4 v247, s[4:7], s66 offen sc1 lds
  s_add_u32 m0, s63, 49152
  s_add_u32 s66, s62, 163840
  buffer_load_dwordx4 v247, s[4:7], s66 offen sc1 lds
  s_add_u32 m0, s63, 57344
  s_add_u32 s66, s62, 172032
  buffer_load_dwordx4 v247, s[4:7], s66 offen sc1 lds
  v_mov_b32 v250, 98816
  ds_read_b32 v250, v250
  v_mov_b32 v188, -1
  v_mov_b32 v189, -1
  v_mov_b32 v190, -1
  v_mov_b32 v191, -1
  s_lshl_b32 s68, s30, 16
  s_lshl_b32 s69, s34, 10
  s_add_u32 s68, s68, s69
  s_add_u32 s68, s68, 14680064
  buffer_store_dwordx4 v[188:191], v247, s[4:7], s68 offen sc1
  s_waitcnt lgkmcnt(0)
  v_readfirstlane_b32 s28, v250
  s_cmp_eq_u32 s3, 4
  s_cbranch_scc0 La_nfb
  s_add_u32 s56, s74, 16842752
  v_mov_b32 v250, s56
  v_mov_b32 v251, s28
  s_mov_b64 exec, 1
  buffer_store_dword v251, v250, s[4:7], 0 offen sc1
  s_mov_b64 exec, -1
La_nfb:
  v_exp_f32 v96, v96
  v_exp_f32 v97, v97
  v_mfma_f32_32x32x16_bf16 v[32:47], v[164:167], v[156:159], v[32:47]
  v_exp_f32 v98, v98
  v_exp_f32 v99, v99
  v_exp_f32 v100, v100
  v_cvt_pk_bf16_f32 v144, v96, v97
  v_exp_f32 v101, v101
  v_cvt_pk_bf16_f32 v145, v98, v99
  s_waitcnt lgkmcnt(0)
  v_mfma_f32_32x32x16_bf16 v[80:95], v[176:179], v[4:7], v[48:63]
  v_exp_f32 v102, v102
  v_exp_f32 v103, v103
  v_exp_f32 v104, v104
  v_cvt_pk_bf16_f32 v146, v100, v101
  v_exp_f32 v105, v105
  v_cvt_pk_bf16_f32 v147, v102, v103
  v_exp_f32 v106, v106
  v_exp_f32 v107, v107
  v_mfma_f32_32x32x16_bf16 v[16:31], v[168:171], v[144:147], v[16:31]
  v_exp_f32 v108, v108
  v_cvt_pk_bf16_f32 v148, v104, v105
  v_exp_f32 v109, v109
  v_cvt_pk_bf16_f32 v149, v106, v107
  v_exp_f32 v110, v110
  v_exp_f32 v111, v111
  s_mov_b64 exec, s[40:41]
  ds_read_b128 v[160:163], v245 offset:12288
  ds_read_b128 v[164:167], v245 offset:12800
  s_mov_b64 exec, -1
  v_cvt_pk_bf16_f32 v150, v108, v109
  v_cvt_pk_bf16_f32 v151, v110, v111
  v_exp_f32 v128, v128
  v_exp_f32 v129, v129
  v_mfma_f32_32x32x16_bf16 v[16:31], v[172:175], v[148:151], v[16:31]
  v_exp_f32 v130, v130
  v_exp_f32 v131, v131
  v_exp_f32 v132, v132
  v_cvt_pk_bf16_f32 v152, v128, v129
  v_exp_f32 v133, v133
  v_cvt_pk_bf16_f32 v153, v130, v131
  v_mfma_f32_32x32x16_bf16 v[112:127], v[176:179], v[8:11], v[64:79]
  ds_read_b128 v[180:183], v244 offset:14336
  v_exp_f32 v134, v134
  v_exp_f32 v135, v135
  v_exp_f32 v136, v136
  v_cvt_pk_bf16_f32 v154, v132, v133
  v_exp_f32 v137, v137
  v_cvt_pk_bf16_f32 v155, v134, v135
  v_exp_f32 v138, v138
  v_exp_f32 v139, v139
  v_mfma_f32_32x32x16_bf16 v[32:47], v[168:171], v[152:155], v[32:47]
  v_exp_f32 v140, v140
  v_cvt_pk_bf16_f32 v156, v136, v137
  v_exp_f32 v141, v141
  v_cvt_pk_bf16_f32 v157, v138, v139
  v_exp_f32 v142, v142
  v_exp_f32 v143, v143
  v_cvt_pk_bf16_f32 v158, v140, v141
  v_cvt_pk_bf16_f32 v159, v142, v143
  v_exp_f32 v80, v80
  v_exp_f32 v81, v81
  v_mfma_f32_32x32x16_bf16 v[32:47], v[172:175], v[156:159], v[32:47]
  v_exp_f32 v82, v82
  v_exp_f32 v83, v83
  v_exp_f32 v84, v84
  v_cvt_pk_bf16_f32 v144, v80, v81
  v_exp_f32 v85, v85
  v_cvt_pk_bf16_f32 v145, v82, v83
  s_waitcnt lgkmcnt(0)
  v_mfma_f32_32x32x16_bf16 v[96:111], v[180:183], v[4:7], v[48:63]
  v_exp_f32 v86, v86
  v_exp_f32 v87, v87
  v_exp_f32 v88, v88
  v_cvt_pk_bf16_f32 v146, v84, v85
  v_exp_f32 v89, v89
  v_cvt_pk_bf16_f32 v147, v86, v87
  v_exp_f32 v90, v90
  v_exp_f32 v91, v91
  v_mfma_f32_32x32x16_bf16 v[16:31], v[160:163], v[144:147], v[16:31]
  v_exp_f32 v92, v92
  v_cvt_pk_bf16_f32 v148, v88, v89
  v_exp_f32 v93, v93
  v_cvt_pk_bf16_f32 v149, v90, v91
  v_exp_f32 v94, v94
  v_exp_f32 v95, v95
  s_mov_b64 exec, s[40:41]
  ds_read_b128 v[168:171], v245 offset:14336
  ds_read_b128 v[172:175], v245 offset:14848
  s_mov_b64 exec, -1
  v_cvt_pk_bf16_f32 v150, v92, v93
  v_cvt_pk_bf16_f32 v151, v94, v95
  v_exp_f32 v112, v112
  v_exp_f32 v113, v113
  v_mfma_f32_32x32x16_bf16 v[16:31], v[164:167], v[148:151], v[16:31]
  v_exp_f32 v114, v114
  v_exp_f32 v115, v115
  v_exp_f32 v116, v116
  v_cvt_pk_bf16_f32 v152, v112, v113
  v_exp_f32 v117, v117
  v_cvt_pk_bf16_f32 v153, v114, v115
  v_mfma_f32_32x32x16_bf16 v[128:143], v[180:183], v[8:11], v[64:79]
  ds_read_b128 v[176:179], v254 offset:0
  v_exp_f32 v118, v118
  v_exp_f32 v119, v119
  v_exp_f32 v120, v120
  v_cvt_pk_bf16_f32 v154, v116, v117
  v_exp_f32 v121, v121
  v_cvt_pk_bf16_f32 v155, v118, v119
  v_exp_f32 v122, v122
  v_exp_f32 v123, v123
  v_mfma_f32_32x32x16_bf16 v[32:47], v[160:163], v[152:155], v[32:47]
  v_exp_f32 v124, v124
  v_cvt_pk_bf16_f32 v156, v120, v121
  v_exp_f32 v125, v125
  v_cvt_pk_bf16_f32 v157, v122, v123
  v_exp_f32 v126, v126
  v_exp_f32 v127, v127
  v_cvt_pk_bf16_f32 v158, v124, v125
  v_cvt_pk_bf16_f32 v159, v126, v127
  v_exp_f32 v96, v96
  v_exp_f32 v97, v97
  v_mfma_f32_32x32x16_bf16 v[32:47], v[164:167], v[156:159], v[32:47]
  v_exp_f32 v98, v98
  v_exp_f32 v99, v99
  v_exp_f32 v100, v100
  v_cvt_pk_bf16_f32 v144, v96, v97
  v_exp_f32 v101, v101
  v_cvt_pk_bf16_f32 v145, v98, v99
  s_waitcnt lgkmcnt(0)
  v_mfma_f32_32x32x16_bf16 v[80:95], v[176:179], v[4:7], v[48:63]
  v_exp_f32 v102, v102
  v_exp_f32 v103, v103
  v_exp_f32 v104, v104
  v_cvt_pk_bf16_f32 v146, v100, v101
  v_exp_f32 v105, v105
  v_cvt_pk_bf16_f32 v147, v102, v103
  v_exp_f32 v106, v106
  v_exp_f32 v107, v107
  v_mfma_f32_32x32x16_bf16 v[16:31], v[168:171], v[144:147], v[16:31]
  v_exp_f32 v108, v108
  v_cvt_pk_bf16_f32 v148, v104, v105
  v_exp_f32 v109, v109
  v_cvt_pk_bf16_f32 v149, v106, v107
  v_exp_f32 v110, v110
  v_exp_f32 v111, v111
  s_mov_b64 exec, s[40:41]
  ds_read_b128 v[160:163], v255 offset:0
  ds_read_b128 v[164:167], v255 offset:512
  s_mov_b64 exec, -1
  v_cvt_pk_bf16_f32 v150, v108, v109
  v_cvt_pk_bf16_f32 v151, v110, v111
  v_exp_f32 v128, v128
  v_exp_f32 v129, v129
  v_mfma_f32_32x32x16_bf16 v[16:31], v[172:175], v[148:151], v[16:31]
  v_exp_f32 v130, v130
  v_exp_f32 v131, v131
  v_exp_f32 v132, v132
  v_cvt_pk_bf16_f32 v152, v128, v129
  v_exp_f32 v133, v133
  v_cvt_pk_bf16_f32 v153, v130, v131
  v_mfma_f32_32x32x16_bf16 v[112:127], v[176:179], v[8:11], v[64:79]
  ds_read_b128 v[180:183], v254 offset:2048
  v_exp_f32 v134, v134
  v_exp_f32 v135, v135
  v_exp_f32 v136, v136
  v_cvt_pk_bf16_f32 v154, v132, v133
  v_exp_f32 v137, v137
  v_cvt_pk_bf16_f32 v155, v134, v135
  v_exp_f32 v138, v138
  v_exp_f32 v139, v139
  v_mfma_f32_32x32x16_bf16 v[32:47], v[168:171], v[152:155], v[32:47]
  v_exp_f32 v140, v140
  v_cvt_pk_bf16_f32 v156, v136, v137
  v_exp_f32 v141, v141
  v_cvt_pk_bf16_f32 v157, v138, v139
  v_exp_f32 v142, v142
  v_exp_f32 v143, v143
  v_cvt_pk_bf16_f32 v158, v140, v141
  v_cvt_pk_bf16_f32 v159, v142, v143
  v_exp_f32 v80, v80
  v_exp_f32 v81, v81
  v_mfma_f32_32x32x16_bf16 v[32:47], v[172:175], v[156:159], v[32:47]
  v_exp_f32 v82, v82
  v_exp_f32 v83, v83
  v_exp_f32 v84, v84
  v_cvt_pk_bf16_f32 v144, v80, v81
  v_exp_f32 v85, v85
  v_cvt_pk_bf16_f32 v145, v82, v83
  s_waitcnt lgkmcnt(0)
  v_mfma_f32_32x32x16_bf16 v[96:111], v[180:183], v[4:7], v[48:63]
  v_exp_f32 v86, v86
  v_exp_f32 v87, v87
  v_exp_f32 v88, v88
  v_cvt_pk_bf16_f32 v146, v84, v85
  v_exp_f32 v89, v89
  v_cvt_pk_bf16_f32 v147, v86, v87
  v_exp_f32 v90, v90
  v_exp_f32 v91, v91
  v_mfma_f32_32x32x16_bf16 v[16:31], v[160:163], v[144:147], v[16:31]
  v_exp_f32 v92, v92
  v_cvt_pk_bf16_f32 v148, v88, v89
  v_exp_f32 v93, v93
  v_cvt_pk_bf16_f32 v149, v90, v91
  v_exp_f32 v94, v94
  v_exp_f32 v95, v95
  s_mov_b64 exec, s[40:41]
  ds_read_b128 v[168:171], v255 offset:2048
  ds_read_b128 v[172:175], v255 offset:2560
  s_mov_b64 exec, -1
  v_cvt_pk_bf16_f32 v150, v92, v93
  v_cvt_pk_bf16_f32 v151, v94, v95
  v_exp_f32 v112, v112
  v_exp_f32 v113, v113
  v_mfma_f32_32x32x16_bf16 v[16:31], v[164:167], v[148:151], v[16:31]
  v_exp_f32 v114, v114
  v_exp_f32 v115, v115
  v_exp_f32 v116, v116
  v_cvt_pk_bf16_f32 v152, v112, v113
  v_exp_f32 v117, v117
  v_cvt_pk_bf16_f32 v153, v114, v115
  v_mfma_f32_32x32x16_bf16 v[128:143], v[180:183], v[8:11], v[64:79]
  ds_read_b128 v[176:179], v254 offset:4096
  v_exp_f32 v118, v118
  v_exp_f32 v119, v119
  v_exp_f32 v120, v120
  v_cvt_pk_bf16_f32 v154, v116, v117
  v_exp_f32 v121, v121
  v_cvt_pk_bf16_f32 v155, v118, v119
  v_exp_f32 v122, v122
  v_exp_f32 v123, v123
  v_mfma_f32_32x32x16_bf16 v[32:47], v[160:163], v[152:155], v[32:47]
  v_exp_f32 v124, v124
  v_cvt_pk_bf16_f32 v156, v120, v121
  v_exp_f32 v125, v125
  v_cvt_pk_bf16_f32 v157, v122, v123
  v_exp_f32 v126, v126
  v_exp_f32 v127, v127
  v_cvt_pk_bf16_f32 v158, v124, v125
  v_cvt_pk_bf16_f32 v159, v126, v127
  v_exp_f32 v96, v96
  v_exp_f32 v97, v97
  v_mfma_f32_32x32x16_bf16 v[32:47], v[164:167], v[156:159], v[32:47]
  v_exp_f32 v98, v98
  v_exp_f32 v99, v99
  v_exp_f32 v100, v100
  v_cvt_pk_bf16_f32 v144, v96, v97
  v_exp_f32 v101, v101
  v_cvt_pk_bf16_f32 v145, v98, v99
  s_waitcnt lgkmcnt(0)
  v_mfma_f32_32x32x16_bf16 v[80:95], v[176:179], v[4:7], v[48:63]
  v_exp_f32 v102, v102
  v_exp_f32 v103, v103
  v_exp_f32 v104, v104
  v_cvt_pk_bf16_f32 v146, v100, v101
  v_exp_f32 v105, v105
  v_cvt_pk_bf16_f32 v147, v102, v103
  v_exp_f32 v106, v106
  v_exp_f32 v107, v107
  v_mfma_f32_32x32x16_bf16 v[16:31], v[168:171], v[144:147], v[16:31]
  v_exp_f32 v108, v108
  v_cvt_pk_bf16_f32 v148, v104, v105
  v_exp_f32 v109, v109
  v_cvt_pk_bf16_f32 v149, v106, v107
  v_exp_f32 v110, v110
  v_exp_f32 v111, v111
  s_mov_b64 exec, s[40:41]
  ds_read_b128 v[160:163], v255 offset:4096
  ds_read_b128 v[164:167], v255 offset:4608
  s_mov_b64 exec, -1
  v_cvt_pk_bf16_f32 v150, v108, v109
  v_cvt_pk_bf16_f32 v151, v110, v111
  v_exp_f32 v128, v128
  v_exp_f32 v129, v129
  v_mfma_f32_32x32x16_bf16 v[16:31], v[172:175], v[148:151], v[16:31]
  v_exp_f32 v130, v130
  v_exp_f32 v131, v131
  v_exp_f32 v132, v132
  v_cvt_pk_bf16_f32 v152, v128, v129
  v_exp_f32 v133, v133
  v_cvt_pk_bf16_f32 v153, v130, v131
  v_mfma_f32_32x32x16_bf16 v[112:127], v[176:179], v[8:11], v[64:79]
  ds_read_b128 v[180:183], v254 offset:6144
  v_exp_f32 v134, v134
  v_exp_f32 v135, v135
  v_exp_f32 v136, v136
  v_cvt_pk_bf16_f32 v154, v132, v133
  v_exp_f32 v137, v137
  v_cvt_pk_bf16_f32 v155, v134, v135
  v_exp_f32 v138, v138
  v_exp_f32 v139, v139
  v_mfma_f32_32x32x16_bf16 v[32:47], v[168:171], v[152:155], v[32:47]
  v_exp_f32 v140, v140
  v_cvt_pk_bf16_f32 v156, v136, v137
  v_exp_f32 v141, v141
  v_cvt_pk_bf16_f32 v157, v138, v139
  v_exp_f32 v142, v142
  v_exp_f32 v143, v143
  v_cvt_pk_bf16_f32 v158, v140, v141
  v_cvt_pk_bf16_f32 v159, v142, v143
  v_exp_f32 v80, v80
  v_exp_f32 v81, v81
  v_mfma_f32_32x32x16_bf16 v[32:47], v[172:175], v[156:159], v[32:47]
  v_exp_f32 v82, v82
  v_exp_f32 v83, v83
  v_exp_f32 v84, v84
  v_cvt_pk_bf16_f32 v144, v80, v81
  v_exp_f32 v85, v85
  v_cvt_pk_bf16_f32 v145, v82, v83
  s_waitcnt lgkmcnt(0)
  v_mfma_f32_32x32x16_bf16 v[96:111], v[180:183], v[4:7], v[48:63]
  v_exp_f32 v86, v86
  v_exp_f32 v87, v87
  v_exp_f32 v88, v88
  v_cvt_pk_bf16_f32 v146, v84, v85
  v_exp_f32 v89, v89
  v_cvt_pk_bf16_f32 v147, v86, v87
  v_exp_f32 v90, v90
  v_exp_f32 v91, v91
  v_mfma_f32_32x32x16_bf16 v[16:31], v[160:163], v[144:147], v[16:31]
  v_exp_f32 v92, v92
  v_cvt_pk_bf16_f32 v148, v88, v89
  v_exp_f32 v93, v93
  v_cvt_pk_bf16_f32 v149, v90, v91
  v_exp_f32 v94, v94
  v_exp_f32 v95, v95
  s_mov_b64 exec, s[40:41]
  ds_read_b128 v[168:171], v255 offset:6144
  ds_read_b128 v[172:175], v255 offset:6656
  s_mov_b64 exec, -1
  v_cvt_pk_bf16_f32 v150, v92, v93
  v_cvt_pk_bf16_f32 v151, v94, v95
  v_exp_f32 v112, v112
  v_exp_f32 v113, v113
  v_mfma_f32_32x32x16_bf16 v[16:31], v[164:167], v[148:151], v[16:31]
  v_exp_f32 v114, v114
  v_exp_f32 v115, v115
  v_exp_f32 v116, v116
  v_cvt_pk_bf16_f32 v152, v112, v113
  v_exp_f32 v117, v117
  v_cvt_pk_bf16_f32 v153, v114, v115
  v_mfma_f32_32x32x16_bf16 v[128:143], v[180:183], v[8:11], v[64:79]
  ds_read_b128 v[176:179], v254 offset:8192
  v_exp_f32 v118, v118
  v_exp_f32 v119, v119
  v_exp_f32 v120, v120
  v_cvt_pk_bf16_f32 v154, v116, v117
  v_exp_f32 v121, v121
  v_cvt_pk_bf16_f32 v155, v118, v119
  v_exp_f32 v122, v122
  v_exp_f32 v123, v123
  v_mfma_f32_32x32x16_bf16 v[32:47], v[160:163], v[152:155], v[32:47]
  v_exp_f32 v124, v124
  v_cvt_pk_bf16_f32 v156, v120, v121
  v_exp_f32 v125, v125
  v_cvt_pk_bf16_f32 v157, v122, v123
  v_exp_f32 v126, v126
  v_exp_f32 v127, v127
  v_cvt_pk_bf16_f32 v158, v124, v125
  v_cvt_pk_bf16_f32 v159, v126, v127
  v_exp_f32 v96, v96
  v_exp_f32 v97, v97
  v_mfma_f32_32x32x16_bf16 v[32:47], v[164:167], v[156:159], v[32:47]
  v_exp_f32 v98, v98
  v_exp_f32 v99, v99
  v_exp_f32 v100, v100
  v_cvt_pk_bf16_f32 v144, v96, v97
  v_exp_f32 v101, v101
  v_cvt_pk_bf16_f32 v145, v98, v99
  s_waitcnt lgkmcnt(0)
  v_mfma_f32_32x32x16_bf16 v[80:95], v[176:179], v[4:7], v[48:63]
  v_exp_f32 v102, v102
  v_exp_f32 v103, v103
  v_exp_f32 v104, v104
  v_cvt_pk_bf16_f32 v146, v100, v101
  v_exp_f32 v105, v105
  v_cvt_pk_bf16_f32 v147, v102, v103
  v_exp_f32 v106, v106
  v_exp_f32 v107, v107
  v_mfma_f32_32x32x16_bf16 v[16:31], v[168:171], v[144:147], v[16:31]
  v_exp_f32 v108, v108
  v_cvt_pk_bf16_f32 v148, v104, v105
  v_exp_f32 v109, v109
  v_cvt_pk_bf16_f32 v149, v106, v107
  v_exp_f32 v110, v110
  v_exp_f32 v111, v111
  s_mov_b64 exec, s[40:41]
  ds_read_b128 v[160:163], v255 offset:8192
  ds_read_b128 v[164:167], v255 offset:8704
  s_mov_b64 exec, -1
  v_cvt_pk_bf16_f32 v150, v108, v109
  v_cvt_pk_bf16_f32 v151, v110, v111
  v_exp_f32 v128, v128
  v_exp_f32 v129, v129
  v_mfma_f32_32x32x16_bf16 v[16:31], v[172:175], v[148:151], v[16:31]
  v_exp_f32 v130, v130
  v_exp_f32 v131, v131
  v_exp_f32 v132, v132
  v_cvt_pk_bf16_f32 v152, v128, v129
  v_exp_f32 v133, v133
  v_cvt_pk_bf16_f32 v153, v130, v131
  v_mfma_f32_32x32x16_bf16 v[112:127], v[176:179], v[8:11], v[64:79]
  ds_read_b128 v[180:183], v254 offset:10240
  v_exp_f32 v134, v134
  v_exp_f32 v135, v135
  v_exp_f32 v136, v136
  v_cvt_pk_bf16_f32 v154, v132, v133
  v_exp_f32 v137, v137
  v_cvt_pk_bf16_f32 v155, v134, v135
  v_exp_f32 v138, v138
  v_exp_f32 v139, v139
  v_mfma_f32_32x32x16_bf16 v[32:47], v[168:171], v[152:155], v[32:47]
  v_exp_f32 v140, v140
  v_cvt_pk_bf16_f32 v156, v136, v137
  v_exp_f32 v141, v141
  v_cvt_pk_bf16_f32 v157, v138, v139
  v_exp_f32 v142, v142
  v_exp_f32 v143, v143
  v_cvt_pk_bf16_f32 v158, v140, v141
  v_cvt_pk_bf16_f32 v159, v142, v143
  v_exp_f32 v80, v80
  v_exp_f32 v81, v81
  v_mfma_f32_32x32x16_bf16 v[32:47], v[172:175], v[156:159], v[32:47]
  v_exp_f32 v82, v82
  v_exp_f32 v83, v83
  v_exp_f32 v84, v84
  v_cvt_pk_bf16_f32 v144, v80, v81
  v_exp_f32 v85, v85
  v_cvt_pk_bf16_f32 v145, v82, v83
  s_waitcnt lgkmcnt(0)
  v_mfma_f32_32x32x16_bf16 v[96:111], v[180:183], v[4:7], v[48:63]
  v_exp_f32 v86, v86
  v_exp_f32 v87, v87
  v_exp_f32 v88, v88
  v_cvt_pk_bf16_f32 v146, v84, v85
  v_exp_f32 v89, v89
  v_cvt_pk_bf16_f32 v147, v86, v87
  v_exp_f32 v90, v90
  v_exp_f32 v91, v91
  v_mfma_f32_32x32x16_bf16 v[16:31], v[160:163], v[144:147], v[16:31]
  v_exp_f32 v92, v92
  v_cvt_pk_bf16_f32 v148, v88, v89
  v_exp_f32 v93, v93
  v_cvt_pk_bf16_f32 v149, v90, v91
  v_exp_f32 v94, v94
  v_exp_f32 v95, v95
  s_mov_b64 exec, s[40:41]
  ds_read_b128 v[168:171], v255 offset:10240
  ds_read_b128 v[172:175], v255 offset:10752
  s_mov_b64 exec, -1
  v_cvt_pk_bf16_f32 v150, v92, v93
  v_cvt_pk_bf16_f32 v151, v94, v95
  v_exp_f32 v112, v112
  v_exp_f32 v113, v113
  v_mfma_f32_32x32x16_bf16 v[16:31], v[164:167], v[148:151], v[16:31]
  v_exp_f32 v114, v114
  v_exp_f32 v115, v115
  v_exp_f32 v116, v116
  v_cvt_pk_bf16_f32 v152, v112, v113
  v_exp_f32 v117, v117
  v_cvt_pk_bf16_f32 v153, v114, v115
  v_mfma_f32_32x32x16_bf16 v[128:143], v[180:183], v[8:11], v[64:79]
  ds_read_b128 v[176:179], v254 offset:12288
  v_exp_f32 v118, v118
  v_exp_f32 v119, v119
  v_exp_f32 v120, v120
  v_cvt_pk_bf16_f32 v154, v116, v117
  v_exp_f32 v121, v121
  v_cvt_pk_bf16_f32 v155, v118, v119
  v_exp_f32 v122, v122
  v_exp_f32 v123, v123
  v_mfma_f32_32x32x16_bf16 v[32:47], v[160:163], v[152:155], v[32:47]
  v_exp_f32 v124, v124
  v_cvt_pk_bf16_f32 v156, v120, v121
  v_exp_f32 v125, v125
  v_cvt_pk_bf16_f32 v157, v122, v123
  v_exp_f32 v126, v126
  v_exp_f32 v127, v127
  v_cvt_pk_bf16_f32 v158, v124, v125
  v_cvt_pk_bf16_f32 v159, v126, v127
  s_waitcnt vmcnt(0)
  s_barrier
  s_add_u32 m0, s63, 65536
  s_add_u32 s66, s62, 114688
  buffer_load_dwordx4 v247, s[4:7], s66 offen sc1 lds
  s_add_u32 m0, s63, 73728
  s_add_u32 s66, s62, 122880
  buffer_load_dwordx4 v247, s[4:7], s66 offen sc1 lds
  s_add_u32 m0, s63, 81920
  s_add_u32 s66, s62, 180224
  buffer_load_dwordx4 v247, s[4:7], s66 offen sc1 lds
  s_add_u32 m0, s63, 90112
  s_add_u32 s66, s62, 188416
  buffer_load_dwordx4 v247, s[4:7], s66 offen sc1 lds
  v_exp_f32 v96, v96
  v_exp_f32 v97, v97
  v_mfma_f32_32x32x16_bf16 v[32:47], v[164:167], v[156:159], v[32:47]
  v_exp_f32 v98, v98
  v_exp_f32 v99, v99
  v_exp_f32 v100, v100
  v_cvt_pk_bf16_f32 v144, v96, v97
  v_exp_f32 v101, v101
  v_cvt_pk_bf16_f32 v145, v98, v99
  s_waitcnt lgkmcnt(0)
  v_mfma_f32_32x32x16_bf16 v[80:95], v[176:179], v[4:7], v[48:63]
  v_exp_f32 v102, v102
  v_exp_f32 v103, v103
  v_exp_f32 v104, v104
  v_cvt_pk_bf16_f32 v146, v100, v101
  v_exp_f32 v105, v105
  v_cvt_pk_bf16_f32 v147, v102, v103
  v_exp_f32 v106, v106
  v_exp_f32 v107, v107
  v_mfma_f32_32x32x16_bf16 v[16:31], v[168:171], v[144:147], v[16:31]
  v_exp_f32 v108, v108
  v_cvt_pk_bf16_f32 v148, v104, v105
  v_exp_f32 v109, v109
  v_cvt_pk_bf16_f32 v149, v106, v107
  v_exp_f32 v110, v110
  v_exp_f32 v111, v111
  s_mov_b64 exec, s[40:41]
  ds_read_b128 v[160:163], v255 offset:12288
  ds_read_b128 v[164:167], v255 offset:12800
  s_mov_b64 exec, -1
  v_cvt_pk_bf16_f32 v150, v108, v109
  v_cvt_pk_bf16_f32 v151, v110, v111
  v_exp_f32 v128, v128
  v_exp_f32 v129, v129
  v_mfma_f32_32x32x16_bf16 v[16:31], v[172:175], v[148:151], v[16:31]
  v_exp_f32 v130, v130
  v_exp_f32 v131, v131
  v_exp_f32 v132, v132
  v_cvt_pk_bf16_f32 v152, v128, v129
  v_exp_f32 v133, v133
  v_cvt_pk_bf16_f32 v153, v130, v131
  v_mfma_f32_32x32x16_bf16 v[112:127], v[176:179], v[8:11], v[64:79]
  ds_read_b128 v[180:183], v254 offset:14336
  v_exp_f32 v134, v134
  v_exp_f32 v135, v135
  v_exp_f32 v136, v136
  v_cvt_pk_bf16_f32 v154, v132, v133
  v_exp_f32 v137, v137
  v_cvt_pk_bf16_f32 v155, v134, v135
  v_exp_f32 v138, v138
  v_exp_f32 v139, v139
  v_mfma_f32_32x32x16_bf16 v[32:47], v[168:171], v[152:155], v[32:47]
  v_exp_f32 v140, v140
  v_cvt_pk_bf16_f32 v156, v136, v137
  v_exp_f32 v141, v141
  v_cvt_pk_bf16_f32 v157, v138, v139
  v_exp_f32 v142, v142
  v_exp_f32 v143, v143
  v_cvt_pk_bf16_f32 v158, v140, v141
  v_cvt_pk_bf16_f32 v159, v142, v143
  v_exp_f32 v80, v80
  v_exp_f32 v81, v81
  v_mfma_f32_32x32x16_bf16 v[32:47], v[172:175], v[156:159], v[32:47]
  v_exp_f32 v82, v82
  v_exp_f32 v83, v83
  v_exp_f32 v84, v84
  v_cvt_pk_bf16_f32 v144, v80, v81
  v_exp_f32 v85, v85
  v_cvt_pk_bf16_f32 v145, v82, v83
  s_waitcnt lgkmcnt(0)
  v_mfma_f32_32x32x16_bf16 v[96:111], v[180:183], v[4:7], v[48:63]
  v_exp_f32 v86, v86
  v_exp_f32 v87, v87
  v_exp_f32 v88, v88
  v_cvt_pk_bf16_f32 v146, v84, v85
  v_exp_f32 v89, v89
  v_cvt_pk_bf16_f32 v147, v86, v87
  v_exp_f32 v90, v90
  v_exp_f32 v91, v91
  v_mfma_f32_32x32x16_bf16 v[16:31], v[160:163], v[144:147], v[16:31]
  v_exp_f32 v92, v92
  v_cvt_pk_bf16_f32 v148, v88, v89
  v_exp_f32 v93, v93
  v_cvt_pk_bf16_f32 v149, v90, v91
  v_exp_f32 v94, v94
  v_exp_f32 v95, v95
  s_mov_b64 exec, s[40:41]
  ds_read_b128 v[168:171], v255 offset:14336
  ds_read_b128 v[172:175], v255 offset:14848
  s_mov_b64 exec, -1
  v_cvt_pk_bf16_f32 v150, v92, v93
  v_cvt_pk_bf16_f32 v151, v94, v95
  v_exp_f32 v112, v112
  v_exp_f32 v113, v113
  v_mfma_f32_32x32x16_bf16 v[16:31], v[164:167], v[148:151], v[16:31]
  v_exp_f32 v114, v114
  v_exp_f32 v115, v115
  v_exp_f32 v116, v116
  v_cvt_pk_bf16_f32 v152, v112, v113
  v_exp_f32 v117, v117
  v_cvt_pk_bf16_f32 v153, v114, v115
  v_mfma_f32_32x32x16_bf16 v[128:143], v[180:183], v[8:11], v[64:79]
  ds_read_b128 v[176:179], v254 offset:32768
  v_exp_f32 v118, v118
  v_exp_f32 v119, v119
  v_exp_f32 v120, v120
  v_cvt_pk_bf16_f32 v154, v116, v117
  v_exp_f32 v121, v121
  v_cvt_pk_bf16_f32 v155, v118, v119
  v_exp_f32 v122, v122
  v_exp_f32 v123, v123
  v_mfma_f32_32x32x16_bf16 v[32:47], v[160:163], v[152:155], v[32:47]
  v_exp_f32 v124, v124
  v_cvt_pk_bf16_f32 v156, v120, v121
  v_exp_f32 v125, v125
  v_cvt_pk_bf16_f32 v157, v122, v123
  v_exp_f32 v126, v126
  v_exp_f32 v127, v127
  v_cvt_pk_bf16_f32 v158, v124, v125
  v_cvt_pk_bf16_f32 v159, v126, v127
  v_exp_f32 v96, v96
  v_exp_f32 v97, v97
  v_mfma_f32_32x32x16_bf16 v[32:47], v[164:167], v[156:159], v[32:47]
  v_exp_f32 v98, v98
  v_exp_f32 v99, v99
  v_exp_f32 v100, v100
  v_cvt_pk_bf16_f32 v144, v96, v97
  v_exp_f32 v101, v101
  v_cvt_pk_bf16_f32 v145, v98, v99
  s_waitcnt lgkmcnt(0)
  v_mfma_f32_32x32x16_bf16 v[80:95], v[176:179], v[4:7], v[48:63]
  v_exp_f32 v102, v102
  v_exp_f32 v103, v103
  v_exp_f32 v104, v104
  v_cvt_pk_bf16_f32 v146, v100, v101
  v_exp_f32 v105, v105
  v_cvt_pk_bf16_f32 v147, v102, v103
  v_exp_f32 v106, v106
  v_exp_f32 v107, v107
  v_mfma_f32_32x32x16_bf16 v[16:31], v[168:171], v[144:147], v[16:31]
  v_exp_f32 v108, v108
  v_cvt_pk_bf16_f32 v148, v104, v105
  v_exp_f32 v109, v109
  v_cvt_pk_bf16_f32 v149, v106, v107
  v_exp_f32 v110, v110
  v_exp_f32 v111, v111
  s_mov_b64 exec, s[40:41]
  ds_read_b128 v[160:163], v255 offset:32768
  ds_read_b128 v[164:167], v255 offset:33280
  s_mov_b64 exec, -1
  v_cvt_pk_bf16_f32 v150, v108, v109
  v_cvt_pk_bf16_f32 v151, v110, v111
  v_exp_f32 v128, v128
  v_exp_f32 v129, v129
  v_mfma_f32_32x32x16_bf16 v[16:31], v[172:175], v[148:151], v[16:31]
  v_exp_f32 v130, v130
  v_exp_f32 v131, v131
  v_exp_f32 v132, v132
  v_cvt_pk_bf16_f32 v152, v128, v129
  v_exp_f32 v133, v133
  v_cvt_pk_bf16_f32 v153, v130, v131
  v_mfma_f32_32x32x16_bf16 v[112:127], v[176:179], v[8:11], v[64:79]
  ds_read_b128 v[180:183], v254 offset:34816
  v_exp_f32 v134, v134
  v_exp_f32 v135, v135
  v_exp_f32 v136, v136
  v_cvt_pk_bf16_f32 v154, v132, v133
  v_exp_f32 v137, v137
  v_cvt_pk_bf16_f32 v155, v134, v135
  v_exp_f32 v138, v138
  v_exp_f32 v139, v139
  v_mfma_f32_32x32x16_bf16 v[32:47], v[168:171], v[152:155], v[32:47]
  v_exp_f32 v140, v140
  v_cvt_pk_bf16_f32 v156, v136, v137
  v_exp_f32 v141, v141
  v_cvt_pk_bf16_f32 v157, v138, v139
  v_exp_f32 v142, v142
  v_exp_f32 v143, v143
  v_cvt_pk_bf16_f32 v158, v140, v141
  v_cvt_pk_bf16_f32 v159, v142, v143
  v_exp_f32 v80, v80
  v_exp_f32 v81, v81
  v_mfma_f32_32x32x16_bf16 v[32:47], v[172:175], v[156:159], v[32:47]
  v_exp_f32 v82, v82
  v_exp_f32 v83, v83
  v_exp_f32 v84, v84
  v_cvt_pk_bf16_f32 v144, v80, v81
  v_exp_f32 v85, v85
  v_cvt_pk_bf16_f32 v145, v82, v83
  s_waitcnt lgkmcnt(0)
  v_mfma_f32_32x32x16_bf16 v[96:111], v[180:183], v[4:7], v[48:63]
  v_exp_f32 v86, v86
  v_exp_f32 v87, v87
  v_exp_f32 v88, v88
  v_cvt_pk_bf16_f32 v146, v84, v85
  v_exp_f32 v89, v89
  v_cvt_pk_bf16_f32 v147, v86, v87
  v_exp_f32 v90, v90
  v_exp_f32 v91, v91
  v_mfma_f32_32x32x16_bf16 v[16:31], v[160:163], v[144:147], v[16:31]
  v_exp_f32 v92, v92
  v_cvt_pk_bf16_f32 v148, v88, v89
  v_exp_f32 v93, v93
  v_cvt_pk_bf16_f32 v149, v90, v91
  v_exp_f32 v94, v94
  v_exp_f32 v95, v95
  s_mov_b64 exec, s[40:41]
  ds_read_b128 v[168:171], v255 offset:34816
  ds_read_b128 v[172:175], v255 offset:35328
  s_mov_b64 exec, -1
  v_cvt_pk_bf16_f32 v150, v92, v93
  v_cvt_pk_bf16_f32 v151, v94, v95
  v_exp_f32 v112, v112
  v_exp_f32 v113, v113
  v_mfma_f32_32x32x16_bf16 v[16:31], v[164:167], v[148:151], v[16:31]
  v_exp_f32 v114, v114
  v_exp_f32 v115, v115
  v_exp_f32 v116, v116
  v_cvt_pk_bf16_f32 v152, v112, v113
  v_exp_f32 v117, v117
  v_cvt_pk_bf16_f32 v153, v114, v115
  v_mfma_f32_32x32x16_bf16 v[128:143], v[180:183], v[8:11], v[64:79]
  ds_read_b128 v[176:179], v254 offset:36864
  v_exp_f32 v118, v118
  v_exp_f32 v119, v119
  v_exp_f32 v120, v120
  v_cvt_pk_bf16_f32 v154, v116, v117
  v_exp_f32 v121, v121
  v_cvt_pk_bf16_f32 v155, v118, v119
  v_exp_f32 v122, v122
  v_exp_f32 v123, v123
  v_mfma_f32_32x32x16_bf16 v[32:47], v[160:163], v[152:155], v[32:47]
  v_exp_f32 v124, v124
  v_cvt_pk_bf16_f32 v156, v120, v121
  v_exp_f32 v125, v125
  v_cvt_pk_bf16_f32 v157, v122, v123
  v_exp_f32 v126, v126
  v_exp_f32 v127, v127
  v_cvt_pk_bf16_f32 v158, v124, v125
  v_cvt_pk_bf16_f32 v159, v126, v127
  s_cmp_lt_u32 s3, 4
  s_cbranch_scc1 La_s17
  buffer_load_dword v252, v2, s[4:7], 0 offen sc1
La_s17:
  v_exp_f32 v96, v96
  v_exp_f32 v97, v97
  v_mfma_f32_32x32x16_bf16 v[32:47], v[164:167], v[156:159], v[32:47]
  v_exp_f32 v98, v98
  v_exp_f32 v99, v99
  v_exp_f32 v100, v100
  v_cvt_pk_bf16_f32 v144, v96, v97
  v_exp_f32 v101, v101
  v_cvt_pk_bf16_f32 v145, v98, v99
  s_waitcnt lgkmcnt(0)
  v_mfma_f32_32x32x16_bf16 v[80:95], v[176:179], v[4:7], v[48:63]
  v_exp_f32 v102, v102
  v_exp_f32 v103, v103
  v_exp_f32 v104, v104
  v_cvt_pk_bf16_f32 v146, v100, v101
  v_exp_f32 v105, v105
  v_cvt_pk_bf16_f32 v147, v102, v103
  v_exp_f32 v106, v106
  v_exp_f32 v107, v107
  v_mfma_f32_32x32x16_bf16 v[16:31], v[168:171], v[144:147], v[16:31]
  v_exp_f32 v108, v108
  v_cvt_pk_bf16_f32 v148, v104, v105
  v_exp_f32 v109, v109
  v_cvt_pk_bf16_f32 v149, v106, v107
  v_exp_f32 v110, v110
  v_exp_f32 v111, v111
  s_mov_b64 exec, s[40:41]
  ds_read_b128 v[160:163], v255 offset:36864
  ds_read_b128 v[164:167], v255 offset:37376
  s_mov_b64 exec, -1
  v_cvt_pk_bf16_f32 v150, v108, v109
  v_cvt_pk_bf16_f32 v151, v110, v111
  v_exp_f32 v128, v128
  v_exp_f32 v129, v129
  v_mfma_f32_32x32x16_bf16 v[16:31], v[172:175], v[148:151], v[16:31]
  v_exp_f32 v130, v130
  v_exp_f32 v131, v131
  v_exp_f32 v132, v132
  v_cvt_pk_bf16_f32 v152, v128, v129
  v_exp_f32 v133, v133
  v_cvt_pk_bf16_f32 v153, v130, v131
  v_mfma_f32_32x32x16_bf16 v[112:127], v[176:179], v[8:11], v[64:79]
  ds_read_b128 v[180:183], v254 offset:38912
  v_exp_f32 v134, v134
  v_exp_f32 v135, v135
  v_exp_f32 v136, v136
  v_cvt_pk_bf16_f32 v154, v132, v133
  v_exp_f32 v137, v137
  v_cvt_pk_bf16_f32 v155, v134, v135
  v_exp_f32 v138, v138
  v_exp_f32 v139, v139
  v_mfma_f32_32x32x16_bf16 v[32:47], v[168:171], v[152:155], v[32:47]
  v_exp_f32 v140, v140
  v_cvt_pk_bf16_f32 v156, v136, v137
  v_exp_f32 v141, v141
  v_cvt_pk_bf16_f32 v157, v138, v139
  v_exp_f32 v142, v142
  v_exp_f32 v143, v143
  v_cvt_pk_bf16_f32 v158, v140, v141
  v_cvt_pk_bf16_f32 v159, v142, v143
  v_exp_f32 v80, v80
  v_exp_f32 v81, v81
  v_mfma_f32_32x32x16_bf16 v[32:47], v[172:175], v[156:159], v[32:47]
  v_exp_f32 v82, v82
  v_exp_f32 v83, v83
  v_exp_f32 v84, v84
  v_cvt_pk_bf16_f32 v144, v80, v81
  v_exp_f32 v85, v85
  v_cvt_pk_bf16_f32 v145, v82, v83
  s_waitcnt lgkmcnt(0)
  v_mfma_f32_32x32x16_bf16 v[96:111], v[180:183], v[4:7], v[48:63]
  v_exp_f32 v86, v86
  v_exp_f32 v87, v87
  v_exp_f32 v88, v88
  v_cvt_pk_bf16_f32 v146, v84, v85
  v_exp_f32 v89, v89
  v_cvt_pk_bf16_f32 v147, v86, v87
  v_exp_f32 v90, v90
  v_exp_f32 v91, v91
  v_mfma_f32_32x32x16_bf16 v[16:31], v[160:163], v[144:147], v[16:31]
  v_exp_f32 v92, v92
  v_cvt_pk_bf16_f32 v148, v88, v89
  v_exp_f32 v93, v93
  v_cvt_pk_bf16_f32 v149, v90, v91
  v_exp_f32 v94, v94
  v_exp_f32 v95, v95
  s_mov_b64 exec, s[40:41]
  ds_read_b128 v[168:171], v255 offset:38912
  ds_read_b128 v[172:175], v255 offset:39424
  s_mov_b64 exec, -1
  v_cvt_pk_bf16_f32 v150, v92, v93
  v_cvt_pk_bf16_f32 v151, v94, v95
  v_exp_f32 v112, v112
  v_exp_f32 v113, v113
  v_mfma_f32_32x32x16_bf16 v[16:31], v[164:167], v[148:151], v[16:31]
  v_exp_f32 v114, v114
  v_exp_f32 v115, v115
  v_exp_f32 v116, v116
  v_cvt_pk_bf16_f32 v152, v112, v113
  v_exp_f32 v117, v117
  v_cvt_pk_bf16_f32 v153, v114, v115
  v_mfma_f32_32x32x16_bf16 v[128:143], v[180:183], v[8:11], v[64:79]
  ds_read_b128 v[176:179], v254 offset:40960
  v_exp_f32 v118, v118
  v_exp_f32 v119, v119
  v_exp_f32 v120, v120
  v_cvt_pk_bf16_f32 v154, v116, v117
  v_exp_f32 v121, v121
  v_cvt_pk_bf16_f32 v155, v118, v119
  v_exp_f32 v122, v122
  v_exp_f32 v123, v123
  v_mfma_f32_32x32x16_bf16 v[32:47], v[160:163], v[152:155], v[32:47]
  v_exp_f32 v124, v124
  v_cvt_pk_bf16_f32 v156, v120, v121
  v_exp_f32 v125, v125
  v_cvt_pk_bf16_f32 v157, v122, v123
  v_exp_f32 v126, v126
  v_exp_f32 v127, v127
  v_cvt_pk_bf16_f32 v158, v124, v125
  v_cvt_pk_bf16_f32 v159, v126, v127
  v_exp_f32 v96, v96
  v_exp_f32 v97, v97
  v_mfma_f32_32x32x16_bf16 v[32:47], v[164:167], v[156:159], v[32:47]
  v_exp_f32 v98, v98
  v_exp_f32 v99, v99
  v_exp_f32 v100, v100
  v_cvt_pk_bf16_f32 v144, v96, v97
  v_exp_f32 v101, v101
  v_cvt_pk_bf16_f32 v145, v98, v99
  s_waitcnt lgkmcnt(0)
  v_mfma_f32_32x32x16_bf16 v[80:95], v[176:179], v[4:7], v[48:63]
  v_exp_f32 v102, v102
  v_exp_f32 v103, v103
  v_exp_f32 v104, v104
  v_cvt_pk_bf16_f32 v146, v100, v101
  v_exp_f32 v105, v105
  v_cvt_pk_bf16_f32 v147, v102, v103
  v_exp_f32 v106, v106
  v_exp_f32 v107, v107
  v_mfma_f32_32x32x16_bf16 v[16:31], v[168:171], v[144:147], v[16:31]
  v_exp_f32 v108, v108
  v_cvt_pk_bf16_f32 v148, v104, v105
  v_exp_f32 v109, v109
  v_cvt_pk_bf16_f32 v149, v106, v107
  v_exp_f32 v110, v110
  v_exp_f32 v111, v111
  s_mov_b64 exec, s[40:41]
  ds_read_b128 v[160:163], v255 offset:40960
  ds_read_b128 v[164:167], v255 offset:41472
  s_mov_b64 exec, -1
  v_cvt_pk_bf16_f32 v150, v108, v109
  v_cvt_pk_bf16_f32 v151, v110, v111
  v_exp_f32 v128, v128
  v_exp_f32 v129, v129
  v_mfma_f32_32x32x16_bf16 v[16:31], v[172:175], v[148:151], v[16:31]
  v_exp_f32 v130, v130
  v_exp_f32 v131, v131
  v_exp_f32 v132, v132
  v_cvt_pk_bf16_f32 v152, v128, v129
  v_exp_f32 v133, v133
  v_cvt_pk_bf16_f32 v153, v130, v131
  v_mfma_f32_32x32x16_bf16 v[112:127], v[176:179], v[8:11], v[64:79]
  ds_read_b128 v[180:183], v254 offset:43008
  v_exp_f32 v134, v134
  v_exp_f32 v135, v135
  v_exp_f32 v136, v136
  v_cvt_pk_bf16_f32 v154, v132, v133
  v_exp_f32 v137, v137
  v_cvt_pk_bf16_f32 v155, v134, v135
  v_exp_f32 v138, v138
  v_exp_f32 v139, v139
  v_mfma_f32_32x32x16_bf16 v[32:47], v[168:171], v[152:155], v[32:47]
  v_exp_f32 v140, v140
  v_cvt_pk_bf16_f32 v156, v136, v137
  v_exp_f32 v141, v141
  v_cvt_pk_bf16_f32 v157, v138, v139
  v_exp_f32 v142, v142
  v_exp_f32 v143, v143
  v_cvt_pk_bf16_f32 v158, v140, v141
  v_cvt_pk_bf16_f32 v159, v142, v143
  v_exp_f32 v80, v80
  v_exp_f32 v81, v81
  v_mfma_f32_32x32x16_bf16 v[32:47], v[172:175], v[156:159], v[32:47]
  v_exp_f32 v82, v82
  v_exp_f32 v83, v83
  v_exp_f32 v84, v84
  v_cvt_pk_bf16_f32 v144, v80, v81
  v_exp_f32 v85, v85
  v_cvt_pk_bf16_f32 v145, v82, v83
  s_waitcnt lgkmcnt(0)
  v_mfma_f32_32x32x16_bf16 v[96:111], v[180:183], v[4:7], v[48:63]
  v_exp_f32 v86, v86
  v_exp_f32 v87, v87
  v_exp_f32 v88, v88
  v_cvt_pk_bf16_f32 v146, v84, v85
  v_exp_f32 v89, v89
  v_cvt_pk_bf16_f32 v147, v86, v87
  v_exp_f32 v90, v90
  v_exp_f32 v91, v91
  v_mfma_f32_32x32x16_bf16 v[16:31], v[160:163], v[144:147], v[16:31]
  v_exp_f32 v92, v92
  v_cvt_pk_bf16_f32 v148, v88, v89
  v_exp_f32 v93, v93
  v_cvt_pk_bf16_f32 v149, v90, v91
  v_exp_f32 v94, v94
  v_exp_f32 v95, v95
  s_mov_b64 exec, s[40:41]
  ds_read_b128 v[168:171], v255 offset:43008
  ds_read_b128 v[172:175], v255 offset:43520
  s_mov_b64 exec, -1
  v_cvt_pk_bf16_f32 v150, v92, v93
  v_cvt_pk_bf16_f32 v151, v94, v95
  v_exp_f32 v112, v112
  v_exp_f32 v113, v113
  v_mfma_f32_32x32x16_bf16 v[16:31], v[164:167], v[148:151], v[16:31]
  v_exp_f32 v114, v114
  v_exp_f32 v115, v115
  v_exp_f32 v116, v116
  v_cvt_pk_bf16_f32 v152, v112, v113
  v_exp_f32 v117, v117
  v_cvt_pk_bf16_f32 v153, v114, v115
  v_mfma_f32_32x32x16_bf16 v[128:143], v[180:183], v[8:11], v[64:79]
  ds_read_b128 v[176:179], v254 offset:45056
  v_exp_f32 v118, v118
  v_exp_f32 v119, v119
  v_exp_f32 v120, v120
  v_cvt_pk_bf16_f32 v154, v116, v117
  v_exp_f32 v121, v121
  v_cvt_pk_bf16_f32 v155, v118, v119
  v_exp_f32 v122, v122
  v_exp_f32 v123, v123
  v_mfma_f32_32x32x16_bf16 v[32:47], v[160:163], v[152:155], v[32:47]
  v_exp_f32 v124, v124
  v_cvt_pk_bf16_f32 v156, v120, v121
  v_exp_f32 v125, v125
  v_cvt_pk_bf16_f32 v157, v122, v123
  v_exp_f32 v126, v126
  v_exp_f32 v127, v127
  v_cvt_pk_bf16_f32 v158, v124, v125
  v_cvt_pk_bf16_f32 v159, v126, v127
  s_waitcnt vmcnt(1)
  s_barrier
  v_exp_f32 v96, v96
  v_exp_f32 v97, v97
  v_mfma_f32_32x32x16_bf16 v[32:47], v[164:167], v[156:159], v[32:47]
  v_exp_f32 v98, v98
  v_exp_f32 v99, v99
  v_exp_f32 v100, v100
  v_cvt_pk_bf16_f32 v144, v96, v97
  v_exp_f32 v101, v101
  v_cvt_pk_bf16_f32 v145, v98, v99
  s_waitcnt lgkmcnt(0)
  v_mfma_f32_32x32x16_bf16 v[80:95], v[176:179], v[4:7], v[48:63]
  v_exp_f32 v102, v102
  v_exp_f32 v103, v103
  v_exp_f32 v104, v104
  v_cvt_pk_bf16_f32 v146, v100, v101
  v_exp_f32 v105, v105
  v_cvt_pk_bf16_f32 v147, v102, v103
  v_exp_f32 v106, v106
  v_exp_f32 v107, v107
  v_mfma_f32_32x32x16_bf16 v[16:31], v[168:171], v[144:147], v[16:31]
  v_exp_f32 v108, v108
  v_cvt_pk_bf16_f32 v148, v104, v105
  v_exp_f32 v109, v109
  v_cvt_pk_bf16_f32 v149, v106, v107
  v_exp_f32 v110, v110
  v_exp_f32 v111, v111
  s_mov_b64 exec, s[40:41]
  ds_read_b128 v[160:163], v255 offset:45056
  ds_read_b128 v[164:167], v255 offset:45568
  s_mov_b64 exec, -1
  v_cvt_pk_bf16_f32 v150, v108, v109
  v_cvt_pk_bf16_f32 v151, v110, v111
  v_exp_f32 v128, v128
  v_exp_f32 v129, v129
  v_mfma_f32_32x32x16_bf16 v[16:31], v[172:175], v[148:151], v[16:31]
  v_exp_f32 v130, v130
  v_exp_f32 v131, v131
  v_exp_f32 v132, v132
  v_cvt_pk_bf16_f32 v152, v128, v129
  v_exp_f32 v133, v133
  v_cvt_pk_bf16_f32 v153, v130, v131
  v_mfma_f32_32x32x16_bf16 v[112:127], v[176:179], v[8:11], v[64:79]
  ds_read_b128 v[180:183], v254 offset:47104
  v_exp_f32 v134, v134
  v_exp_f32 v135, v135
  v_exp_f32 v136, v136
  v_cvt_pk_bf16_f32 v154, v132, v133
  v_exp_f32 v137, v137
  v_cvt_pk_bf16_f32 v155, v134, v135
  v_exp_f32 v138, v138
  v_exp_f32 v139, v139
  v_mfma_f32_32x32x16_bf16 v[32:47], v[168:171], v[152:155], v[32:47]
  v_exp_f32 v140, v140
  v_cvt_pk_bf16_f32 v156, v136, v137
  v_exp_f32 v141, v141
  v_cvt_pk_bf16_f32 v157, v138, v139
  v_exp_f32 v142, v142
  v_exp_f32 v143, v143
  v_cvt_pk_bf16_f32 v158, v140, v141
  v_cvt_pk_bf16_f32 v159, v142, v143
  v_exp_f32 v80, v80
  v_exp_f32 v81, v81
  v_mfma_f32_32x32x16_bf16 v[32:47], v[172:175], v[156:159], v[32:47]
  v_exp_f32 v82, v82
  v_exp_f32 v83, v83
  v_exp_f32 v84, v84
  v_cvt_pk_bf16_f32 v144, v80, v81
  v_exp_f32 v85, v85
  v_cvt_pk_bf16_f32 v145, v82, v83
  s_waitcnt lgkmcnt(0)
  v_mfma_f32_32x32x16_bf16 v[96:111], v[180:183], v[4:7], v[48:63]
  v_exp_f32 v86, v86
  v_exp_f32 v87, v87
  v_exp_f32 v88, v88
  v_cvt_pk_bf16_f32 v146, v84, v85
  v_exp_f32 v89, v89
  v_cvt_pk_bf16_f32 v147, v86, v87
  v_exp_f32 v90, v90
  v_exp_f32 v91, v91
  v_mfma_f32_32x32x16_bf16 v[16:31], v[160:163], v[144:147], v[16:31]
  v_exp_f32 v92, v92
  v_cvt_pk_bf16_f32 v148, v88, v89
  v_exp_f32 v93, v93
  v_cvt_pk_bf16_f32 v149, v90, v91
  v_exp_f32 v94, v94
  v_exp_f32 v95, v95
  s_mov_b64 exec, s[40:41]
  ds_read_b128 v[168:171], v255 offset:47104
  ds_read_b128 v[172:175], v255 offset:47616
  s_mov_b64 exec, -1
  v_cvt_pk_bf16_f32 v150, v92, v93
  v_cvt_pk_bf16_f32 v151, v94, v95
  v_exp_f32 v112, v112
  v_exp_f32 v113, v113
  v_mfma_f32_32x32x16_bf16 v[16:31], v[164:167], v[148:151], v[16:31]
  v_exp_f32 v114, v114
  v_exp_f32 v115, v115
  v_exp_f32 v116, v116
  v_cvt_pk_bf16_f32 v152, v112, v113
  v_exp_f32 v117, v117
  v_cvt_pk_bf16_f32 v153, v114, v115
  v_mfma_f32_32x32x16_bf16 v[128:143], v[180:183], v[8:11], v[64:79]
  ds_read_b128 v[176:179], v184 offset:0
  v_exp_f32 v118, v118
  v_exp_f32 v119, v119
  v_exp_f32 v120, v120
  v_cvt_pk_bf16_f32 v154, v116, v117
  v_exp_f32 v121, v121
  v_cvt_pk_bf16_f32 v155, v118, v119
  v_exp_f32 v122, v122
  v_exp_f32 v123, v123
  v_mfma_f32_32x32x16_bf16 v[32:47], v[160:163], v[152:155], v[32:47]
  v_exp_f32 v124, v124
  v_cvt_pk_bf16_f32 v156, v120, v121
  v_exp_f32 v125, v125
  v_cvt_pk_bf16_f32 v157, v122, v123
  v_exp_f32 v126, v126
  v_exp_f32 v127, v127
  v_cvt_pk_bf16_f32 v158, v124, v125
  v_cvt_pk_bf16_f32 v159, v126, v127
  v_exp_f32 v96, v96
  v_exp_f32 v97, v97
  v_mfma_f32_32x32x16_bf16 v[32:47], v[164:167], v[156:159], v[32:47]
  v_exp_f32 v98, v98
  v_exp_f32 v99, v99
  v_exp_f32 v100, v100
  v_cvt_pk_bf16_f32 v144, v96, v97
  v_exp_f32 v101, v101
  v_cvt_pk_bf16_f32 v145, v98, v99
  s_waitcnt lgkmcnt(0)
  v_mfma_f32_32x32x16_bf16 v[80:95], v[176:179], v[4:7], v[48:63]
  v_exp_f32 v102, v102
  v_exp_f32 v103, v103
  v_exp_f32 v104, v104
  v_cvt_pk_bf16_f32 v146, v100, v101
  v_exp_f32 v105, v105
  v_cvt_pk_bf16_f32 v147, v102, v103
  v_exp_f32 v106, v106
  v_exp_f32 v107, v107
  v_mfma_f32_32x32x16_bf16 v[16:31], v[168:171], v[144:147], v[16:31]
  v_exp_f32 v108, v108
  v_cvt_pk_bf16_f32 v148, v104, v105
  v_exp_f32 v109, v109
  v_cvt_pk_bf16_f32 v149, v106, v107
  v_exp_f32 v110, v110
  v_exp_f32 v111, v111
  s_mov_b64 exec, s[40:41]
  ds_read_b128 v[160:163], v185 offset:0
  ds_read_b128 v[164:167], v185 offset:512
  s_mov_b64 exec, -1
  v_cvt_pk_bf16_f32 v150, v108, v109
  v_cvt_pk_bf16_f32 v151, v110, v111
  v_exp_f32 v128, v128
  v_exp_f32 v129, v129
  v_mfma_f32_32x32x16_bf16 v[16:31], v[172:175], v[148:151], v[16:31]
  v_exp_f32 v130, v130
  v_exp_f32 v131, v131
  v_exp_f32 v132, v132
  v_cvt_pk_bf16_f32 v152, v128, v129
  v_exp_f32 v133, v133
  v_cvt_pk_bf16_f32 v153, v130, v131
  v_mfma_f32_32x32x16_bf16 v[112:127], v[176:179], v[8:11], v[64:79]
  ds_read_b128 v[180:183], v184 offset:2048
  v_exp_f32 v134, v134
  v_exp_f32 v135, v135
  v_exp_f32 v136, v136
  v_cvt_pk_bf16_f32 v154, v132, v133
  v_exp_f32 v137, v137
  v_cvt_pk_bf16_f32 v155, v134, v135
  v_exp_f32 v138, v138
  v_exp_f32 v139, v139
  v_mfma_f32_32x32x16_bf16 v[32:47], v[168:171], v[152:155], v[32:47]
  v_exp_f32 v140, v140
  v_cvt_pk_bf16_f32 v156, v136, v137
  v_exp_f32 v141, v141
  v_cvt_pk_bf16_f32 v157, v138, v139
  v_exp_f32 v142, v142
  v_exp_f32 v143, v143
  v_cvt_pk_bf16_f32 v158, v140, v141
  v_cvt_pk_bf16_f32 v159, v142, v143
  v_exp_f32 v80, v80
  v_exp_f32 v81, v81
  v_mfma_f32_32x32x16_bf16 v[32:47], v[172:175], v[156:159], v[32:47]
  v_exp_f32 v82, v82
  v_exp_f32 v83, v83
  v_exp_f32 v84, v84
  v_cvt_pk_bf16_f32 v144, v80, v81
  v_exp_f32 v85, v85
  v_cvt_pk_bf16_f32 v145, v82, v83
  s_waitcnt lgkmcnt(0)
  v_mfma_f32_32x32x16_bf16 v[96:111], v[180:183], v[4:7], v[48:63]
  v_exp_f32 v86, v86
  v_exp_f32 v87, v87
  v_exp_f32 v88, v88
  v_cvt_pk_bf16_f32 v146, v84, v85
  v_exp_f32 v89, v89
  v_cvt_pk_bf16_f32 v147, v86, v87
  v_exp_f32 v90, v90
  v_exp_f32 v91, v91
  v_mfma_f32_32x32x16_bf16 v[16:31], v[160:163], v[144:147], v[16:31]
  v_exp_f32 v92, v92
  v_cvt_pk_bf16_f32 v148, v88, v89
  v_exp_f32 v93, v93
  v_cvt_pk_bf16_f32 v149, v90, v91
  v_exp_f32 v94, v94
  v_exp_f32 v95, v95
  s_mov_b64 exec, s[40:41]
  ds_read_b128 v[168:171], v185 offset:2048
  ds_read_b128 v[172:175], v185 offset:2560
  s_mov_b64 exec, -1
  v_cvt_pk_bf16_f32 v150, v92, v93
  v_cvt_pk_bf16_f32 v151, v94, v95
  v_exp_f32 v112, v112
  v_exp_f32 v113, v113
  v_mfma_f32_32x32x16_bf16 v[16:31], v[164:167], v[148:151], v[16:31]
  v_exp_f32 v114, v114
  v_exp_f32 v115, v115
  v_exp_f32 v116, v116
  v_cvt_pk_bf16_f32 v152, v112, v113
  v_exp_f32 v117, v117
  v_cvt_pk_bf16_f32 v153, v114, v115
  v_mfma_f32_32x32x16_bf16 v[128:143], v[180:183], v[8:11], v[64:79]
  ds_read_b128 v[176:179], v184 offset:4096
  v_exp_f32 v118, v118
  v_exp_f32 v119, v119
  v_exp_f32 v120, v120
  v_cvt_pk_bf16_f32 v154, v116, v117
  v_exp_f32 v121, v121
  v_cvt_pk_bf16_f32 v155, v118, v119
  v_exp_f32 v122, v122
  v_exp_f32 v123, v123
  v_mfma_f32_32x32x16_bf16 v[32:47], v[160:163], v[152:155], v[32:47]
  v_exp_f32 v124, v124
  v_cvt_pk_bf16_f32 v156, v120, v121
  v_exp_f32 v125, v125
  v_cvt_pk_bf16_f32 v157, v122, v123
  v_exp_f32 v126, v126
  v_exp_f32 v127, v127
  v_cvt_pk_bf16_f32 v158, v124, v125
  v_cvt_pk_bf16_f32 v159, v126, v127
  s_cmp_lt_u32 s3, 4
  s_cbranch_scc1 La_s25
  s_mov_b32 s67, 65536
La_bspin:
  s_waitcnt vmcnt(0)
  v_cmp_eq_u32 vcc, s28, v252
  s_nop 4
  s_cmp_eq_u64 vcc, -1
  s_cbranch_scc1 La_bgot
  s_sleep 1
  buffer_load_dword v252, v2, s[4:7], 0 offen sc1
  s_sub_u32 s67, s67, 1
  s_cmp_lg_u32 s67, 0
  s_cbranch_scc1 La_bspin
  s_waitcnt vmcnt(0)
La_bgot:
  s_sub_u32 s51, s3, 4
  s_lshl_b32 s51, s51, 10
  s_lshl_b32 s50, s31, 14
  s_add_u32 s50, s50, s51
  s_sub_u32 s50, s50, 16384
  s_add_u32 m0, s51, 131072
  s_add_u32 s54, s50, 0
  s_max_i32 s54, s54, 0
  s_add_u32 s54, s54, s36
  s_add_u32 s54, s54, 65536
  buffer_load_dwordx4 v247, s[4:7], s54 offen sc1 lds
  s_add_u32 m0, s51, 135168
  s_add_u32 s54, s50, 4096
  s_max_i32 s54, s54, 0
  s_add_u32 s54, s54, s36
  s_add_u32 s54, s54, 65536
  buffer_load_dwordx4 v247, s[4:7], s54 offen sc1 lds
  s_add_u32 m0, s51, 139264
  s_add_u32 s54, s50, 8192
  s_max_i32 s54, s54, 0
  s_add_u32 s54, s54, s36
  s_add_u32 s54, s54, 65536
  buffer_load_dwordx4 v247, s[4:7], s54 offen sc1 lds
  s_add_u32 m0, s51, 143360
  s_add_u32 s54, s50, 12288
  s_max_i32 s54, s54, 0
  s_add_u32 s54, s54, s36
  s_add_u32 s54, s54, 65536
  buffer_load_dwordx4 v247, s[4:7], s54 offen sc1 lds
  s_add_u32 m0, s51, 147456
  s_add_u32 s54, s50, 16384
  s_max_i32 s54, s54, 0
  s_add_u32 s54, s54, s36
  s_add_u32 s54, s54, 65536
  buffer_load_dwordx4 v247, s[4:7], s54 offen sc1 lds
  s_add_u32 m0, s51, 151552
  s_add_u32 s54, s50, 20480
  s_max_i32 s54, s54, 0
  s_add_u32 s54, s54, s36
  s_add_u32 s54, s54, 65536
  buffer_load_dwordx4 v247, s[4:7], s54 offen sc1 lds
  s_add_u32 m0, s51, 155648
  s_add_u32 s54, s50, 24576
  s_max_i32 s54, s54, 0
  s_add_u32 s54, s54, s36
  s_add_u32 s54, s54, 65536
  buffer_load_dwordx4 v247, s[4:7], s54 offen sc1 lds
  s_add_u32 m0, s51, 159744
  s_add_u32 s54, s50, 28672
  s_max_i32 s54, s54, 0
  s_add_u32 s54, s54, s36
  s_add_u32 s54, s54, 65536
  buffer_load_dwordx4 v247, s[4:7], s54 offen sc1 lds
  s_lshl_b32 s50, s31, 13
  s_add_u32 s50, s50, s36
  s_add_u32 s50, s50, s51
  s_add_u32 m0, s51, 122880
  s_add_u32 s54, s50, 0
  buffer_load_dwordx4 v247, s[4:7], s54 offen sc1 lds
  s_add_u32 m0, s51, 126976
  s_add_u32 s54, s50, 4096
  buffer_load_dwordx4 v247, s[4:7], s54 offen sc1 lds
La_s25:
  v_exp_f32 v96, v96
  v_exp_f32 v97, v97
  v_mfma_f32_32x32x16_bf16 v[32:47], v[164:167], v[156:159], v[32:47]
  v_exp_f32 v98, v98
  v_exp_f32 v99, v99
  v_exp_f32 v100, v100
  v_cvt_pk_bf16_f32 v144, v96, v97
  v_exp_f32 v101, v101
  v_cvt_pk_bf16_f32 v145, v98, v99
  s_waitcnt lgkmcnt(0)
  v_mfma_f32_32x32x16_bf16 v[80:95], v[176:179], v[4:7], v[48:63]
  v_exp_f32 v102, v102
  v_exp_f32 v103, v103
  v_exp_f32 v104, v104
  v_cvt_pk_bf16_f32 v146, v100, v101
  v_exp_f32 v105, v105
  v_cvt_pk_bf16_f32 v147, v102, v103
  v_exp_f32 v106, v106
  v_exp_f32 v107, v107
  v_mfma_f32_32x32x16_bf16 v[16:31], v[168:171], v[144:147], v[16:31]
  v_exp_f32 v108, v108
  v_cvt_pk_bf16_f32 v148, v104, v105
  v_exp_f32 v109, v109
  v_cvt_pk_bf16_f32 v149, v106, v107
  v_exp_f32 v110, v110
  v_exp_f32 v111, v111
  s_mov_b64 exec, s[40:41]
  ds_read_b128 v[160:163], v185 offset:4096
  ds_read_b128 v[164:167], v185 offset:4608
  s_mov_b64 exec, -1
  v_cvt_pk_bf16_f32 v150, v108, v109
  v_cvt_pk_bf16_f32 v151, v110, v111
  v_exp_f32 v128, v128
  v_exp_f32 v129, v129
  v_mfma_f32_32x32x16_bf16 v[16:31], v[172:175], v[148:151], v[16:31]
  v_exp_f32 v130, v130
  v_exp_f32 v131, v131
  v_exp_f32 v132, v132
  v_cvt_pk_bf16_f32 v152, v128, v129
  v_exp_f32 v133, v133
  v_cvt_pk_bf16_f32 v153, v130, v131
  v_mfma_f32_32x32x16_bf16 v[112:127], v[176:179], v[8:11], v[64:79]
  ds_read_b128 v[180:183], v184 offset:6144
  v_exp_f32 v134, v134
  v_exp_f32 v135, v135
  v_exp_f32 v136, v136
  v_cvt_pk_bf16_f32 v154, v132, v133
  v_exp_f32 v137, v137
  v_cvt_pk_bf16_f32 v155, v134, v135
  v_exp_f32 v138, v138
  v_exp_f32 v139, v139
  v_mfma_f32_32x32x16_bf16 v[32:47], v[168:171], v[152:155], v[32:47]
  v_exp_f32 v140, v140
  v_cvt_pk_bf16_f32 v156, v136, v137
  v_exp_f32 v141, v141
  v_cvt_pk_bf16_f32 v157, v138, v139
  v_exp_f32 v142, v142
  v_exp_f32 v143, v143
  v_cvt_pk_bf16_f32 v158, v140, v141
  v_cvt_pk_bf16_f32 v159, v142, v143
  v_exp_f32 v80, v80
  v_exp_f32 v81, v81
  v_mfma_f32_32x32x16_bf16 v[32:47], v[172:175], v[156:159], v[32:47]
  v_exp_f32 v82, v82
  v_exp_f32 v83, v83
  v_exp_f32 v84, v84
  v_cvt_pk_bf16_f32 v144, v80, v81
  v_exp_f32 v85, v85
  v_cvt_pk_bf16_f32 v145, v82, v83
  s_waitcnt lgkmcnt(0)
  v_mfma_f32_32x32x16_bf16 v[96:111], v[180:183], v[4:7], v[48:63]
  v_exp_f32 v86, v86
  v_exp_f32 v87, v87
  v_exp_f32 v88, v88
  v_cvt_pk_bf16_f32 v146, v84, v85
  v_exp_f32 v89, v89
  v_cvt_pk_bf16_f32 v147, v86, v87
  v_exp_f32 v90, v90
  v_exp_f32 v91, v91
  v_mfma_f32_32x32x16_bf16 v[16:31], v[160:163], v[144:147], v[16:31]
  v_exp_f32 v92, v92
  v_cvt_pk_bf16_f32 v148, v88, v89
  v_exp_f32 v93, v93
  v_cvt_pk_bf16_f32 v149, v90, v91
  v_exp_f32 v94, v94
  v_exp_f32 v95, v95
  s_mov_b64 exec, s[40:41]
  ds_read_b128 v[168:171], v185 offset:6144
  ds_read_b128 v[172:175], v185 offset:6656
  s_mov_b64 exec, -1
  v_cvt_pk_bf16_f32 v150, v92, v93
  v_cvt_pk_bf16_f32 v151, v94, v95
  v_exp_f32 v112, v112
  v_exp_f32 v113, v113
  v_mfma_f32_32x32x16_bf16 v[16:31], v[164:167], v[148:151], v[16:31]
  v_exp_f32 v114, v114
  v_exp_f32 v115, v115
  v_exp_f32 v116, v116
  v_cvt_pk_bf16_f32 v152, v112, v113
  v_exp_f32 v117, v117
  v_cvt_pk_bf16_f32 v153, v114, v115
  v_mfma_f32_32x32x16_bf16 v[128:143], v[180:183], v[8:11], v[64:79]
  ds_read_b128 v[176:179], v184 offset:8192
  v_exp_f32 v118, v118
  v_exp_f32 v119, v119
  v_exp_f32 v120, v120
  v_cvt_pk_bf16_f32 v154, v116, v117
  v_exp_f32 v121, v121
  v_cvt_pk_bf16_f32 v155, v118, v119
  v_exp_f32 v122, v122
  v_exp_f32 v123, v123
  v_mfma_f32_32x32x16_bf16 v[32:47], v[160:163], v[152:155], v[32:47]
  v_exp_f32 v124, v124
  v_cvt_pk_bf16_f32 v156, v120, v121
  v_exp_f32 v125, v125
  v_cvt_pk_bf16_f32 v157, v122, v123
  v_exp_f32 v126, v126
  v_exp_f32 v127, v127
  v_cvt_pk_bf16_f32 v158, v124, v125
  v_cvt_pk_bf16_f32 v159, v126, v127
  s_add_u32 m0, s63, 0
  s_add_u32 s66, s42, 0
  buffer_load_dwordx4 v0, s[8:11], s66 offen lds
  s_add_u32 m0, s63, 8192
  s_add_u32 s66, s42, 65536
  buffer_load_dwordx4 v0, s[8:11], s66 offen lds
  s_add_u32 m0, s63, 16384
  s_add_u32 s66, s42, 131072
  buffer_load_dwordx4 v0, s[8:11], s66 offen lds
  s_add_u32 m0, s63, 24576
  s_add_u32 s66, s42, 196608
  buffer_load_dwordx4 v0, s[8:11], s66 offen lds
  v_exp_f32 v96, v96
  v_exp_f32 v97, v97
  v_mfma_f32_32x32x16_bf16 v[32:47], v[164:167], v[156:159], v[32:47]
  v_exp_f32 v98, v98
  v_exp_f32 v99, v99
  v_exp_f32 v100, v100
  v_cvt_pk_bf16_f32 v144, v96, v97
  v_exp_f32 v101, v101
  v_cvt_pk_bf16_f32 v145, v98, v99
  s_waitcnt lgkmcnt(0)
  v_mfma_f32_32x32x16_bf16 v[80:95], v[176:179], v[4:7], v[48:63]
  v_exp_f32 v102, v102
  v_exp_f32 v103, v103
  v_exp_f32 v104, v104
  v_cvt_pk_bf16_f32 v146, v100, v101
  v_exp_f32 v105, v105
  v_cvt_pk_bf16_f32 v147, v102, v103
  v_exp_f32 v106, v106
  v_exp_f32 v107, v107
  v_mfma_f32_32x32x16_bf16 v[16:31], v[168:171], v[144:147], v[16:31]
  v_exp_f32 v108, v108
  v_cvt_pk_bf16_f32 v148, v104, v105
  v_exp_f32 v109, v109
  v_cvt_pk_bf16_f32 v149, v106, v107
  v_exp_f32 v110, v110
  v_exp_f32 v111, v111
  s_mov_b64 exec, s[40:41]
  ds_read_b128 v[160:163], v185 offset:8192
  ds_read_b128 v[164:167], v185 offset:8704
  s_mov_b64 exec, -1
  v_cvt_pk_bf16_f32 v150, v108, v109
  v_cvt_pk_bf16_f32 v151, v110, v111
  v_exp_f32 v128, v128
  v_exp_f32 v129, v129
  v_mfma_f32_32x32x16_bf16 v[16:31], v[172:175], v[148:151], v[16:31]
  v_exp_f32 v130, v130
  v_exp_f32 v131, v131
  v_exp_f32 v132, v132
  v_cvt_pk_bf16_f32 v152, v128, v129
  v_exp_f32 v133, v133
  v_cvt_pk_bf16_f32 v153, v130, v131
  v_mfma_f32_32x32x16_bf16 v[112:127], v[176:179], v[8:11], v[64:79]
  ds_read_b128 v[180:183], v184 offset:10240
  v_exp_f32 v134, v134
  v_exp_f32 v135, v135
  v_exp_f32 v136, v136
  v_cvt_pk_bf16_f32 v154, v132, v133
  v_exp_f32 v137, v137
  v_cvt_pk_bf16_f32 v155, v134, v135
  v_exp_f32 v138, v138
  v_exp_f32 v139, v139
  v_mfma_f32_32x32x16_bf16 v[32:47], v[168:171], v[152:155], v[32:47]
  v_exp_f32 v140, v140
  v_cvt_pk_bf16_f32 v156, v136, v137
  v_exp_f32 v141, v141
  v_cvt_pk_bf16_f32 v157, v138, v139
  v_exp_f32 v142, v142
  v_exp_f32 v143, v143
  v_cvt_pk_bf16_f32 v158, v140, v141
  v_cvt_pk_bf16_f32 v159, v142, v143
  v_exp_f32 v80, v80
  v_exp_f32 v81, v81
  v_mfma_f32_32x32x16_bf16 v[32:47], v[172:175], v[156:159], v[32:47]
  v_exp_f32 v82, v82
  v_exp_f32 v83, v83
  v_exp_f32 v84, v84
  v_cvt_pk_bf16_f32 v144, v80, v81
  v_exp_f32 v85, v85
  v_cvt_pk_bf16_f32 v145, v82, v83
  s_waitcnt lgkmcnt(0)
  v_mfma_f32_32x32x16_bf16 v[96:111], v[180:183], v[4:7], v[48:63]
  v_exp_f32 v86, v86
  v_exp_f32 v87, v87
  v_exp_f32 v88, v88
  v_cvt_pk_bf16_f32 v146, v84, v85
  v_exp_f32 v89, v89
  v_cvt_pk_bf16_f32 v147, v86, v87
  v_exp_f32 v90, v90
  v_exp_f32 v91, v91
  v_mfma_f32_32x32x16_bf16 v[16:31], v[160:163], v[144:147], v[16:31]
  v_exp_f32 v92, v92
  v_cvt_pk_bf16_f32 v148, v88, v89
  v_exp_f32 v93, v93
  v_cvt_pk_bf16_f32 v149, v90, v91
  v_exp_f32 v94, v94
  v_exp_f32 v95, v95
  s_mov_b64 exec, s[40:41]
  ds_read_b128 v[168:171], v185 offset:10240
  ds_read_b128 v[172:175], v185 offset:10752
  s_mov_b64 exec, -1
  v_cvt_pk_bf16_f32 v150, v92, v93
  v_cvt_pk_bf16_f32 v151, v94, v95
  v_exp_f32 v112, v112
  v_exp_f32 v113, v113
  v_mfma_f32_32x32x16_bf16 v[16:31], v[164:167], v[148:151], v[16:31]
  v_exp_f32 v114, v114
  v_exp_f32 v115, v115
  v_exp_f32 v116, v116
  v_cvt_pk_bf16_f32 v152, v112, v113
  v_exp_f32 v117, v117
  v_cvt_pk_bf16_f32 v153, v114, v115
  v_mfma_f32_32x32x16_bf16 v[128:143], v[180:183], v[8:11], v[64:79]
  ds_read_b128 v[176:179], v184 offset:12288
  v_exp_f32 v118, v118
  v_exp_f32 v119, v119
  v_exp_f32 v120, v120
  v_cvt_pk_bf16_f32 v154, v116, v117
  v_exp_f32 v121, v121
  v_cvt_pk_bf16_f32 v155, v118, v119
  v_exp_f32 v122, v122
  v_exp_f32 v123, v123
  v_mfma_f32_32x32x16_bf16 v[32:47], v[160:163], v[152:155], v[32:47]
  v_exp_f32 v124, v124
  v_cvt_pk_bf16_f32 v156, v120, v121
  v_exp_f32 v125, v125
  v_cvt_pk_bf16_f32 v157, v122, v123
  v_exp_f32 v126, v126
  v_exp_f32 v127, v127
  v_cvt_pk_bf16_f32 v158, v124, v125
  v_cvt_pk_bf16_f32 v159, v126, v127
  v_exp_f32 v96, v96
  v_exp_f32 v97, v97
  v_mfma_f32_32x32x16_bf16 v[32:47], v[164:167], v[156:159], v[32:47]
  v_exp_f32 v98, v98
  v_exp_f32 v99, v99
  v_exp_f32 v100, v100
  v_cvt_pk_bf16_f32 v144, v96, v97
  v_exp_f32 v101, v101
  v_cvt_pk_bf16_f32 v145, v98, v99
  s_waitcnt lgkmcnt(0)
  v_mfma_f32_32x32x16_bf16 v[80:95], v[176:179], v[4:7], v[48:63]
  v_exp_f32 v102, v102
  v_exp_f32 v103, v103
  v_exp_f32 v104, v104
  v_cvt_pk_bf16_f32 v146, v100, v101
  v_exp_f32 v105, v105
  v_cvt_pk_bf16_f32 v147, v102, v103
  v_exp_f32 v106, v106
  v_exp_f32 v107, v107
  v_mfma_f32_32x32x16_bf16 v[16:31], v[168:171], v[144:147], v[16:31]
  v_exp_f32 v108, v108
  v_cvt_pk_bf16_f32 v148, v104, v105
  v_exp_f32 v109, v109
  v_cvt_pk_bf16_f32 v149, v106, v107
  v_exp_f32 v110, v110
  v_exp_f32 v111, v111
  s_mov_b64 exec, s[40:41]
  ds_read_b128 v[160:163], v185 offset:12288
  ds_read_b128 v[164:167], v185 offset:12800
  s_mov_b64 exec, -1
  v_cvt_pk_bf16_f32 v150, v108, v109
  v_cvt_pk_bf16_f32 v151, v110, v111
  v_exp_f32 v128, v128
  v_exp_f32 v129, v129
  v_mfma_f32_32x32x16_bf16 v[16:31], v[172:175], v[148:151], v[16:31]
  v_exp_f32 v130, v130
  v_exp_f32 v131, v131
  v_exp_f32 v132, v132
  v_cvt_pk_bf16_f32 v152, v128, v129
  v_exp_f32 v133, v133
  v_cvt_pk_bf16_f32 v153, v130, v131
  v_mfma_f32_32x32x16_bf16 v[112:127], v[176:179], v[8:11], v[64:79]
  ds_read_b128 v[180:183], v184 offset:14336
  v_exp_f32 v134, v134
  v_exp_f32 v135, v135
  v_exp_f32 v136, v136
  v_cvt_pk_bf16_f32 v154, v132, v133
  v_exp_f32 v137, v137
  v_cvt_pk_bf16_f32 v155, v134, v135
  v_exp_f32 v138, v138
  v_exp_f32 v139, v139
  v_mfma_f32_32x32x16_bf16 v[32:47], v[168:171], v[152:155], v[32:47]
  v_exp_f32 v140, v140
  v_cvt_pk_bf16_f32 v156, v136, v137
  v_exp_f32 v141, v141
  v_cvt_pk_bf16_f32 v157, v138, v139
  v_exp_f32 v142, v142
  v_exp_f32 v143, v143
  v_cvt_pk_bf16_f32 v158, v140, v141
  v_cvt_pk_bf16_f32 v159, v142, v143
  v_exp_f32 v80, v80
  v_exp_f32 v81, v81
  v_mfma_f32_32x32x16_bf16 v[32:47], v[172:175], v[156:159], v[32:47]
  v_exp_f32 v82, v82
  v_exp_f32 v83, v83
  v_exp_f32 v84, v84
  v_cvt_pk_bf16_f32 v144, v80, v81
  v_exp_f32 v85, v85
  v_cvt_pk_bf16_f32 v145, v82, v83
  s_waitcnt lgkmcnt(0)
  v_mfma_f32_32x32x16_bf16 v[96:111], v[180:183], v[4:7], v[48:63]
  v_exp_f32 v86, v86
  v_exp_f32 v87, v87
  v_exp_f32 v88, v88
  v_cvt_pk_bf16_f32 v146, v84, v85
  v_exp_f32 v89, v89
  v_cvt_pk_bf16_f32 v147, v86, v87
  v_exp_f32 v90, v90
  v_exp_f32 v91, v91
  v_mfma_f32_32x32x16_bf16 v[16:31], v[160:163], v[144:147], v[16:31]
  v_exp_f32 v92, v92
  v_cvt_pk_bf16_f32 v148, v88, v89
  v_exp_f32 v93, v93
  v_cvt_pk_bf16_f32 v149, v90, v91
  v_exp_f32 v94, v94
  v_exp_f32 v95, v95
  s_mov_b64 exec, s[40:41]
  ds_read_b128 v[168:171], v185 offset:14336
  ds_read_b128 v[172:175], v185 offset:14848
  s_mov_b64 exec, -1
  v_cvt_pk_bf16_f32 v150, v92, v93
  v_cvt_pk_bf16_f32 v151, v94, v95
  v_exp_f32 v112, v112
  v_exp_f32 v113, v113
  v_mfma_f32_32x32x16_bf16 v[16:31], v[164:167], v[148:151], v[16:31]
  v_exp_f32 v114, v114
  v_exp_f32 v115, v115
  v_exp_f32 v116, v116
  v_cvt_pk_bf16_f32 v152, v112, v113
  v_exp_f32 v117, v117
  v_cvt_pk_bf16_f32 v153, v114, v115
  v_mfma_f32_32x32x16_bf16 v[128:143], v[180:183], v[8:11], v[64:79]
  v_exp_f32 v118, v118
  v_exp_f32 v119, v119
  v_exp_f32 v120, v120
  v_cvt_pk_bf16_f32 v154, v116, v117
  v_exp_f32 v121, v121
  v_cvt_pk_bf16_f32 v155, v118, v119
  v_exp_f32 v122, v122
  v_exp_f32 v123, v123
  v_mfma_f32_32x32x16_bf16 v[32:47], v[160:163], v[152:155], v[32:47]
  v_exp_f32 v124, v124
  v_cvt_pk_bf16_f32 v156, v120, v121
  v_exp_f32 v125, v125
  v_cvt_pk_bf16_f32 v157, v122, v123
  v_exp_f32 v126, v126
  v_exp_f32 v127, v127
  v_cvt_pk_bf16_f32 v158, v124, v125
  v_cvt_pk_bf16_f32 v159, v126, v127
  v_exp_f32 v96, v96
  v_exp_f32 v97, v97
  v_mfma_f32_32x32x16_bf16 v[32:47], v[164:167], v[156:159], v[32:47]
  v_exp_f32 v98, v98
  v_exp_f32 v99, v99
  v_exp_f32 v100, v100
  v_cvt_pk_bf16_f32 v144, v96, v97
  v_exp_f32 v101, v101
  v_cvt_pk_bf16_f32 v145, v98, v99
  s_waitcnt lgkmcnt(0)
  v_exp_f32 v102, v102
  v_exp_f32 v103, v103
  v_exp_f32 v104, v104
  v_cvt_pk_bf16_f32 v146, v100, v101
  v_exp_f32 v105, v105
  v_cvt_pk_bf16_f32 v147, v102, v103
  v_exp_f32 v106, v106
  v_exp_f32 v107, v107
  v_mfma_f32_32x32x16_bf16 v[16:31], v[168:171], v[144:147], v[16:31]
  v_exp_f32 v108, v108
  v_cvt_pk_bf16_f32 v148, v104, v105
  v_exp_f32 v109, v109
  v_cvt_pk_bf16_f32 v149, v106, v107
  v_exp_f32 v110, v110
  v_exp_f32 v111, v111
  s_nop 0
  v_cvt_pk_bf16_f32 v150, v108, v109
  v_cvt_pk_bf16_f32 v151, v110, v111
  v_exp_f32 v128, v128
  v_exp_f32 v129, v129
  v_mfma_f32_32x32x16_bf16 v[16:31], v[172:175], v[148:151], v[16:31]
  v_exp_f32 v130, v130
  v_exp_f32 v131, v131
  v_exp_f32 v132, v132
  v_cvt_pk_bf16_f32 v152, v128, v129
  v_exp_f32 v133, v133
  v_cvt_pk_bf16_f32 v153, v130, v131
  v_exp_f32 v134, v134
  v_exp_f32 v135, v135
  v_exp_f32 v136, v136
  v_cvt_pk_bf16_f32 v154, v132, v133
  v_exp_f32 v137, v137
  v_cvt_pk_bf16_f32 v155, v134, v135
  v_exp_f32 v138, v138
  v_exp_f32 v139, v139
  v_mfma_f32_32x32x16_bf16 v[32:47], v[168:171], v[152:155], v[32:47]
  v_exp_f32 v140, v140
  v_cvt_pk_bf16_f32 v156, v136, v137
  v_exp_f32 v141, v141
  v_cvt_pk_bf16_f32 v157, v138, v139
  v_exp_f32 v142, v142
  v_exp_f32 v143, v143
  v_cvt_pk_bf16_f32 v158, v140, v141
  v_cvt_pk_bf16_f32 v159, v142, v143
  s_branch La_post
La_rolled:
  v_mov_b32 v16, 0
  v_mov_b32 v17, 0
  v_mov_b32 v18, 0
  v_mov_b32 v19, 0
  v_mov_b32 v20, 0
  v_mov_b32 v21, 0
  v_mov_b32 v22, 0
  v_mov_b32 v23, 0
  v_mov_b32 v24, 0
  v_mov_b32 v25, 0
  v_mov_b32 v26, 0
  v_mov_b32 v27, 0
  v_mov_b32 v28, 0
  v_mov_b32 v29, 0
  v_mov_b32 v30, 0
  v_mov_b32 v31, 0
  v_mov_b32 v32, 0
  v_mov_b32 v33, 0
  v_mov_b32 v34, 0
  v_mov_b32 v35, 0
  v_mov_b32 v36, 0
  v_mov_b32 v37, 0
  v_mov_b32 v38, 0
  v_mov_b32 v39, 0
  v_mov_b32 v40, 0
  v_mov_b32 v41, 0
  v_mov_b32 v42, 0
  v_mov_b32 v43, 0
  v_mov_b32 v44, 0
  v_mov_b32 v45, 0
  v_mov_b32 v46, 0
  v_mov_b32 v47, 0
  v_mov_b32 v156, 0
  v_mov_b32 v157, 0
  v_mov_b32 v158, 0
  v_mov_b32 v159, 0
  s_mov_b32 s38, 0
La_loop:
  v_exp_f32 v80, v80
  v_exp_f32 v81, v81
  v_mfma_f32_32x32x16_bf16 v[32:47], v[172:175], v[156:159], v[32:47]
  v_exp_f32 v82, v82
  v_exp_f32 v83, v83
  v_exp_f32 v84, v84
  v_cvt_pk_bf16_f32 v144, v80, v81
  v_exp_f32 v85, v85
  v_cvt_pk_bf16_f32 v145, v82, v83
  s_waitcnt lgkmcnt(0)
  v_mfma_f32_32x32x16_bf16 v[96:111], v[180:183], v[4:7], v[48:63]
  v_exp_f32 v86, v86
  v_exp_f32 v87, v87
  v_exp_f32 v88, v88
  v_cvt_pk_bf16_f32 v146, v84, v85
  v_exp_f32 v89, v89
  v_cvt_pk_bf16_f32 v147, v86, v87
  v_exp_f32 v90, v90
  v_exp_f32 v91, v91
  v_mfma_f32_32x32x16_bf16 v[16:31], v[160:163], v[144:147], v[16:31]
  v_exp_f32 v92, v92
  v_cvt_pk_bf16_f32 v148, v88, v89
  v_exp_f32 v93, v93
  v_cvt_pk_bf16_f32 v149, v90, v91
  v_exp_f32 v94, v94
  v_exp_f32 v95, v95
  s_mov_b64 exec, s[40:41]
  ds_read_b128 v[168:171], v245 offset:2048
  ds_read_b128 v[172:175], v245 offset:2560
  s_mov_b64 exec, -1
  v_cvt_pk_bf16_f32 v150, v92, v93
  v_cvt_pk_bf16_f32 v151, v94, v95
  v_exp_f32 v112, v112
  v_exp_f32 v113, v113
  v_mfma_f32_32x32x16_bf16 v[16:31], v[164:167], v[148:151], v[16:31]
  v_exp_f32 v114, v114
  v_exp_f32 v115, v115
  v_exp_f32 v116, v116
  v_cvt_pk_bf16_f32 v152, v112, v113
  v_exp_f32 v117, v117
  v_cvt_pk_bf16_f32 v153, v114, v115
  v_mfma_f32_32x32x16_bf16 v[128:143], v[180:183], v[8:11], v[64:79]
  ds_read_b128 v[176:179], v244 offset:4096
  v_exp_f32 v118, v118
  v_exp_f32 v119, v119
  v_exp_f32 v120, v120
  v_cvt_pk_bf16_f32 v154, v116, v117
  v_exp_f32 v121, v121
  v_cvt_pk_bf16_f32 v155, v118, v119
  v_exp_f32 v122, v122
  v_exp_f32 v123, v123
  v_mfma_f32_32x32x16_bf16 v[32:47], v[160:163], v[152:155], v[32:47]
  v_exp_f32 v124, v124
  v_cvt_pk_bf16_f32 v156, v120, v121
  v_exp_f32 v125, v125
  v_cvt_pk_bf16_f32 v157, v122, v123
  v_exp_f32 v126, v126
  v_exp_f32 v127, v127
  v_cvt_pk_bf16_f32 v158, v124, v125
  v_cvt_pk_bf16_f32 v159, v126, v127
  v_exp_f32 v96, v96
  v_exp_f32 v97, v97
  v_mfma_f32_32x32x16_bf16 v[32:47], v[164:167], v[156:159], v[32:47]
  v_exp_f32 v98, v98
  v_exp_f32 v99, v99
  v_exp_f32 v100, v100
  v_cvt_pk_bf16_f32 v144, v96, v97
  v_exp_f32 v101, v101
  v_cvt_pk_bf16_f32 v145, v98, v99
  s_waitcnt lgkmcnt(0)
  v_mfma_f32_32x32x16_bf16 v[80:95], v[176:179], v[4:7], v[48:63]
  v_exp_f32 v102, v102
  v_exp_f32 v103, v103
  v_exp_f32 v104, v104
  v_cvt_pk_bf16_f32 v146, v100, v101
  v_exp_f32 v105, v105
  v_cvt_pk_bf16_f32 v147, v102, v103
  v_exp_f32 v106, v106
  v_exp_f32 v107, v107
  v_mfma_f32_32x32x16_bf16 v[16:31], v[168:171], v[144:147], v[16:31]
  v_exp_f32 v108, v108
  v_cvt_pk_bf16_f32 v148, v104, v105
  v_exp_f32 v109, v109
  v_cvt_pk_bf16_f32 v149, v106, v107
  v_exp_f32 v110, v110
  v_exp_f32 v111, v111
  s_mov_b64 exec, s[40:41]
  ds_read_b128 v[160:163], v245 offset:4096
  ds_read_b128 v[164:167], v245 offset:4608
  s_mov_b64 exec, -1
  v_cvt_pk_bf16_f32 v150, v108, v109
  v_cvt_pk_bf16_f32 v151, v110, v111
  v_exp_f32 v128, v128
  v_exp_f32 v129, v129
  v_mfma_f32_32x32x16_bf16 v[16:31], v[172:175], v[148:151], v[16:31]
  v_exp_f32 v130, v130
  v_exp_f32 v131, v131
  v_exp_f32 v132, v132
  v_cvt_pk_bf16_f32 v152, v128, v129
  v_exp_f32 v133, v133
  v_cvt_pk_bf16_f32 v153, v130, v131
  v_mfma_f32_32x32x16_bf16 v[112:127], v[176:179], v[8:11], v[64:79]
  ds_read_b128 v[180:183], v244 offset:6144
  v_exp_f32 v134, v134
  v_exp_f32 v135, v135
  v_exp_f32 v136, v136
  v_cvt_pk_bf16_f32 v154, v132, v133
  v_exp_f32 v137, v137
  v_cvt_pk_bf16_f32 v155, v134, v135
  v_exp_f32 v138, v138
  v_exp_f32 v139, v139
  v_mfma_f32_32x32x16_bf16 v[32:47], v[168:171], v[152:155], v[32:47]
  v_exp_f32 v140, v140
  v_cvt_pk_bf16_f32 v156, v136, v137
  v_exp_f32 v141, v141
  v_cvt_pk_bf16_f32 v157, v138, v139
  v_exp_f32 v142, v142
  v_exp_f32 v143, v143
  v_cvt_pk_bf16_f32 v158, v140, v141
  v_cvt_pk_bf16_f32 v159, v142, v143
  v_exp_f32 v80, v80
  v_exp_f32 v81, v81
  v_mfma_f32_32x32x16_bf16 v[32:47], v[172:175], v[156:159], v[32:47]
  v_exp_f32 v82, v82
  v_exp_f32 v83, v83
  v_exp_f32 v84, v84
  v_cvt_pk_bf16_f32 v144, v80, v81
  v_exp_f32 v85, v85
  v_cvt_pk_bf16_f32 v145, v82, v83
  s_waitcnt lgkmcnt(0)
  v_mfma_f32_32x32x16_bf16 v[96:111], v[180:183], v[4:7], v[48:63]
  v_exp_f32 v86, v86
  v_exp_f32 v87, v87
  v_exp_f32 v88, v88
  v_cvt_pk_bf16_f32 v146, v84, v85
  v_exp_f32 v89, v89
  v_cvt_pk_bf16_f32 v147, v86, v87
  v_exp_f32 v90, v90
  v_exp_f32 v91, v91
  v_mfma_f32_32x32x16_bf16 v[16:31], v[160:163], v[144:147], v[16:31]
  v_exp_f32 v92, v92
  v_cvt_pk_bf16_f32 v148, v88, v89
  v_exp_f32 v93, v93
  v_cvt_pk_bf16_f32 v149, v90, v91
  v_exp_f32 v94, v94
  v_exp_f32 v95, v95
  s_mov_b64 exec, s[40:41]
  ds_read_b128 v[168:171], v245 offset:6144
  ds_read_b128 v[172:175], v245 offset:6656
  s_mov_b64 exec, -1
  v_cvt_pk_bf16_f32 v150, v92, v93
  v_cvt_pk_bf16_f32 v151, v94, v95
  v_exp_f32 v112, v112
  v_exp_f32 v113, v113
  v_mfma_f32_32x32x16_bf16 v[16:31], v[164:167], v[148:151], v[16:31]
  v_exp_f32 v114, v114
  v_exp_f32 v115, v115
  v_exp_f32 v116, v116
  v_cvt_pk_bf16_f32 v152, v112, v113
  v_exp_f32 v117, v117
  v_cvt_pk_bf16_f32 v153, v114, v115
  v_mfma_f32_32x32x16_bf16 v[128:143], v[180:183], v[8:11], v[64:79]
  ds_read_b128 v[176:179], v244 offset:8192
  v_exp_f32 v118, v118
  v_exp_f32 v119, v119
  v_exp_f32 v120, v120
  v_cvt_pk_bf16_f32 v154, v116, v117
  v_exp_f32 v121, v121
  v_cvt_pk_bf16_f32 v155, v118, v119
  v_exp_f32 v122, v122
  v_exp_f32 v123, v123
  v_mfma_f32_32x32x16_bf16 v[32:47], v[160:163], v[152:155], v[32:47]
  v_exp_f32 v124, v124
  v_cvt_pk_bf16_f32 v156, v120, v121
  v_exp_f32 v125, v125
  v_cvt_pk_bf16_f32 v157, v122, v123
  v_exp_f32 v126, v126
  v_exp_f32 v127, v127
  v_cvt_pk_bf16_f32 v158, v124, v125
  v_cvt_pk_bf16_f32 v159, v126, v127
  v_exp_f32 v96, v96
  v_exp_f32 v97, v97
  v_mfma_f32_32x32x16_bf16 v[32:47], v[164:167], v[156:159], v[32:47]
  v_exp_f32 v98, v98
  v_exp_f32 v99, v99
  v_exp_f32 v100, v100
  v_cvt_pk_bf16_f32 v144, v96, v97
  v_exp_f32 v101, v101
  v_cvt_pk_bf16_f32 v145, v98, v99
  s_waitcnt lgkmcnt(0)
  v_mfma_f32_32x32x16_bf16 v[80:95], v[176:179], v[4:7], v[48:63]
  v_exp_f32 v102, v102
  v_exp_f32 v103, v103
  v_exp_f32 v104, v104
  v_cvt_pk_bf16_f32 v146, v100, v101
  v_exp_f32 v105, v105
  v_cvt_pk_bf16_f32 v147, v102, v103
  v_exp_f32 v106, v106
  v_exp_f32 v107, v107
  v_mfma_f32_32x32x16_bf16 v[16:31], v[168:171], v[144:147], v[16:31]
  v_exp_f32 v108, v108
  v_cvt_pk_bf16_f32 v148, v104, v105
  v_exp_f32 v109, v109
  v_cvt_pk_bf16_f32 v149, v106, v107
  v_exp_f32 v110, v110
  v_exp_f32 v111, v111
  s_mov_b64 exec, s[40:41]
  ds_read_b128 v[160:163], v245 offset:8192
  ds_read_b128 v[164:167], v245 offset:8704
  s_mov_b64 exec, -1
  v_cvt_pk_bf16_f32 v150, v108, v109
  v_cvt_pk_bf16_f32 v151, v110, v111
  v_exp_f32 v128, v128
  v_exp_f32 v129, v129
  v_mfma_f32_32x32x16_bf16 v[16:31], v[172:175], v[148:151], v[16:31]
  v_exp_f32 v130, v130
  v_exp_f32 v131, v131
  v_exp_f32 v132, v132
  v_cvt_pk_bf16_f32 v152, v128, v129
  v_exp_f32 v133, v133
  v_cvt_pk_bf16_f32 v153, v130, v131
  v_mfma_f32_32x32x16_bf16 v[112:127], v[176:179], v[8:11], v[64:79]
  ds_read_b128 v[180:183], v244 offset:10240
  v_exp_f32 v134, v134
  v_exp_f32 v135, v135
  v_exp_f32 v136, v136
  v_cvt_pk_bf16_f32 v154, v132, v133
  v_exp_f32 v137, v137
  v_cvt_pk_bf16_f32 v155, v134, v135
  v_exp_f32 v138, v138
  v_exp_f32 v139, v139
  v_mfma_f32_32x32x16_bf16 v[32:47], v[168:171], v[152:155], v[32:47]
  v_exp_f32 v140, v140
  v_cvt_pk_bf16_f32 v156, v136, v137
  v_exp_f32 v141, v141
  v_cvt_pk_bf16_f32 v157, v138, v139
  v_exp_f32 v142, v142
  v_exp_f32 v143, v143
  v_cvt_pk_bf16_f32 v158, v140, v141
  v_cvt_pk_bf16_f32 v159, v142, v143
  v_exp_f32 v80, v80
  v_exp_f32 v81, v81
  v_mfma_f32_32x32x16_bf16 v[32:47], v[172:175], v[156:159], v[32:47]
  v_exp_f32 v82, v82
  v_exp_f32 v83, v83
  v_exp_f32 v84, v84
  v_cvt_pk_bf16_f32 v144, v80, v81
  v_exp_f32 v85, v85
  v_cvt_pk_bf16_f32 v145, v82, v83
  s_waitcnt lgkmcnt(0)
  v_mfma_f32_32x32x16_bf16 v[96:111], v[180:183], v[4:7], v[48:63]
  v_exp_f32 v86, v86
  v_exp_f32 v87, v87
  v_exp_f32 v88, v88
  v_cvt_pk_bf16_f32 v146, v84, v85
  v_exp_f32 v89, v89
  v_cvt_pk_bf16_f32 v147, v86, v87
  v_exp_f32 v90, v90
  v_exp_f32 v91, v91
  v_mfma_f32_32x32x16_bf16 v[16:31], v[160:163], v[144:147], v[16:31]
  v_exp_f32 v92, v92
  v_cvt_pk_bf16_f32 v148, v88, v89
  v_exp_f32 v93, v93
  v_cvt_pk_bf16_f32 v149, v90, v91
  v_exp_f32 v94, v94
  v_exp_f32 v95, v95
  s_mov_b64 exec, s[40:41]
  ds_read_b128 v[168:171], v245 offset:10240
  ds_read_b128 v[172:175], v245 offset:10752
  s_mov_b64 exec, -1
  v_cvt_pk_bf16_f32 v150, v92, v93
  v_cvt_pk_bf16_f32 v151, v94, v95
  v_exp_f32 v112, v112
  v_exp_f32 v113, v113
  v_mfma_f32_32x32x16_bf16 v[16:31], v[164:167], v[148:151], v[16:31]
  v_exp_f32 v114, v114
  v_exp_f32 v115, v115
  v_exp_f32 v116, v116
  v_cvt_pk_bf16_f32 v152, v112, v113
  v_exp_f32 v117, v117
  v_cvt_pk_bf16_f32 v153, v114, v115
  v_mfma_f32_32x32x16_bf16 v[128:143], v[180:183], v[8:11], v[64:79]
  ds_read_b128 v[176:179], v244 offset:12288
  v_exp_f32 v118, v118
  v_exp_f32 v119, v119
  v_exp_f32 v120, v120
  v_cvt_pk_bf16_f32 v154, v116, v117
  v_exp_f32 v121, v121
  v_cvt_pk_bf16_f32 v155, v118, v119
  v_exp_f32 v122, v122
  v_exp_f32 v123, v123
  v_mfma_f32_32x32x16_bf16 v[32:47], v[160:163], v[152:155], v[32:47]
  v_exp_f32 v124, v124
  v_cvt_pk_bf16_f32 v156, v120, v121
  v_exp_f32 v125, v125
  v_cvt_pk_bf16_f32 v157, v122, v123
  v_exp_f32 v126, v126
  v_exp_f32 v127, v127
  v_cvt_pk_bf16_f32 v158, v124, v125
  v_cvt_pk_bf16_f32 v159, v126, v127
  v_exp_f32 v96, v96
  v_exp_f32 v97, v97
  v_mfma_f32_32x32x16_bf16 v[32:47], v[164:167], v[156:159], v[32:47]
  v_exp_f32 v98, v98
  v_exp_f32 v99, v99
  v_exp_f32 v100, v100
  v_cvt_pk_bf16_f32 v144, v96, v97
  v_exp_f32 v101, v101
  v_cvt_pk_bf16_f32 v145, v98, v99
  s_waitcnt lgkmcnt(0)
  v_mfma_f32_32x32x16_bf16 v[80:95], v[176:179], v[4:7], v[48:63]
  v_exp_f32 v102, v102
  v_exp_f32 v103, v103
  v_exp_f32 v104, v104
  v_cvt_pk_bf16_f32 v146, v100, v101
  v_exp_f32 v105, v105
  v_cvt_pk_bf16_f32 v147, v102, v103
  v_exp_f32 v106, v106
  v_exp_f32 v107, v107
  v_mfma_f32_32x32x16_bf16 v[16:31], v[168:171], v[144:147], v[16:31]
  v_exp_f32 v108, v108
  v_cvt_pk_bf16_f32 v148, v104, v105
  v_exp_f32 v109, v109
  v_cvt_pk_bf16_f32 v149, v106, v107
  v_exp_f32 v110, v110
  v_exp_f32 v111, v111
  s_mov_b64 exec, s[40:41]
  ds_read_b128 v[160:163], v245 offset:12288
  ds_read_b128 v[164:167], v245 offset:12800
  s_mov_b64 exec, -1
  v_cvt_pk_bf16_f32 v150, v108, v109
  v_cvt_pk_bf16_f32 v151, v110, v111
  v_exp_f32 v128, v128
  v_exp_f32 v129, v129
  v_mfma_f32_32x32x16_bf16 v[16:31], v[172:175], v[148:151], v[16:31]
  v_exp_f32 v130, v130
  v_exp_f32 v131, v131
  v_exp_f32 v132, v132
  v_cvt_pk_bf16_f32 v152, v128, v129
  v_exp_f32 v133, v133
  v_cvt_pk_bf16_f32 v153, v130, v131
  v_mfma_f32_32x32x16_bf16 v[112:127], v[176:179], v[8:11], v[64:79]
  ds_read_b128 v[180:183], v244 offset:14336
  v_exp_f32 v134, v134
  v_exp_f32 v135, v135
  v_exp_f32 v136, v136
  v_cvt_pk_bf16_f32 v154, v132, v133
  v_exp_f32 v137, v137
  v_cvt_pk_bf16_f32 v155, v134, v135
  v_exp_f32 v138, v138
  v_exp_f32 v139, v139
  v_mfma_f32_32x32x16_bf16 v[32:47], v[168:171], v[152:155], v[32:47]
  v_exp_f32 v140, v140
  v_cvt_pk_bf16_f32 v156, v136, v137
  v_exp_f32 v141, v141
  v_cvt_pk_bf16_f32 v157, v138, v139
  v_exp_f32 v142, v142
  v_exp_f32 v143, v143
  v_cvt_pk_bf16_f32 v158, v140, v141
  v_cvt_pk_bf16_f32 v159, v142, v143
  v_exp_f32 v80, v80
  v_exp_f32 v81, v81
  v_mfma_f32_32x32x16_bf16 v[32:47], v[172:175], v[156:159], v[32:47]
  v_exp_f32 v82, v82
  v_exp_f32 v83, v83
  v_exp_f32 v84, v84
  v_cvt_pk_bf16_f32 v144, v80, v81
  v_exp_f32 v85, v85
  v_cvt_pk_bf16_f32 v145, v82, v83
  s_waitcnt lgkmcnt(0)
  v_mfma_f32_32x32x16_bf16 v[96:111], v[180:183], v[4:7], v[48:63]
  v_exp_f32 v86, v86
  v_exp_f32 v87, v87
  v_exp_f32 v88, v88
  v_cvt_pk_bf16_f32 v146, v84, v85
  v_exp_f32 v89, v89
  v_cvt_pk_bf16_f32 v147, v86, v87
  v_exp_f32 v90, v90
  v_exp_f32 v91, v91
  v_mfma_f32_32x32x16_bf16 v[16:31], v[160:163], v[144:147], v[16:31]
  v_exp_f32 v92, v92
  v_cvt_pk_bf16_f32 v148, v88, v89
  v_exp_f32 v93, v93
  v_cvt_pk_bf16_f32 v149, v90, v91
  v_exp_f32 v94, v94
  v_exp_f32 v95, v95
  s_mov_b64 exec, s[40:41]
  ds_read_b128 v[168:171], v245 offset:14336
  ds_read_b128 v[172:175], v245 offset:14848
  s_mov_b64 exec, -1
  v_cvt_pk_bf16_f32 v150, v92, v93
  v_cvt_pk_bf16_f32 v151, v94, v95
  v_exp_f32 v112, v112
  v_exp_f32 v113, v113
  v_mfma_f32_32x32x16_bf16 v[16:31], v[164:167], v[148:151], v[16:31]
  v_exp_f32 v114, v114
  v_exp_f32 v115, v115
  v_exp_f32 v116, v116
  v_cvt_pk_bf16_f32 v152, v112, v113
  v_exp_f32 v117, v117
  v_cvt_pk_bf16_f32 v153, v114, v115
  v_mfma_f32_32x32x16_bf16 v[128:143], v[180:183], v[8:11], v[64:79]
  ds_read_b128 v[176:179], v254 offset:0
  v_exp_f32 v118, v118
  v_exp_f32 v119, v119
  v_exp_f32 v120, v120
  v_cvt_pk_bf16_f32 v154, v116, v117
  v_exp_f32 v121, v121
  v_cvt_pk_bf16_f32 v155, v118, v119
  v_exp_f32 v122, v122
  v_exp_f32 v123, v123
  v_mfma_f32_32x32x16_bf16 v[32:47], v[160:163], v[152:155], v[32:47]
  v_exp_f32 v124, v124
  v_cvt_pk_bf16_f32 v156, v120, v121
  v_exp_f32 v125, v125
  v_cvt_pk_bf16_f32 v157, v122, v123
  v_exp_f32 v126, v126
  v_exp_f32 v127, v127
  v_cvt_pk_bf16_f32 v158, v124, v125
  v_cvt_pk_bf16_f32 v159, v126, v127
  v_exp_f32 v96, v96
  v_exp_f32 v97, v97
  v_mfma_f32_32x32x16_bf16 v[32:47], v[164:167], v[156:159], v[32:47]
  v_exp_f32 v98, v98
  v_exp_f32 v99, v99
  v_exp_f32 v100, v100
  v_cvt_pk_bf16_f32 v144, v96, v97
  v_exp_f32 v101, v101
  v_cvt_pk_bf16_f32 v145, v98, v99
  s_waitcnt lgkmcnt(0)
  v_mfma_f32_32x32x16_bf16 v[80:95], v[176:179], v[4:7], v[48:63]
  v_exp_f32 v102, v102
  v_exp_f32 v103, v103
  v_exp_f32 v104, v104
  v_cvt_pk_bf16_f32 v146, v100, v101
  v_exp_f32 v105, v105
  v_cvt_pk_bf16_f32 v147, v102, v103
  v_exp_f32 v106, v106
  v_exp_f32 v107, v107
  v_mfma_f32_32x32x16_bf16 v[16:31], v[168:171], v[144:147], v[16:31]
  v_exp_f32 v108, v108
  v_cvt_pk_bf16_f32 v148, v104, v105
  v_exp_f32 v109, v109
  v_cvt_pk_bf16_f32 v149, v106, v107
  v_exp_f32 v110, v110
  v_exp_f32 v111, v111
  s_mov_b64 exec, s[40:41]
  ds_read_b128 v[160:163], v255 offset:0
  ds_read_b128 v[164:167], v255 offset:512
  s_mov_b64 exec, -1
  v_cvt_pk_bf16_f32 v150, v108, v109
  v_cvt_pk_bf16_f32 v151, v110, v111
  v_exp_f32 v128, v128
  v_exp_f32 v129, v129
  v_mfma_f32_32x32x16_bf16 v[16:31], v[172:175], v[148:151], v[16:31]
  v_exp_f32 v130, v130
  v_exp_f32 v131, v131
  v_exp_f32 v132, v132
  v_cvt_pk_bf16_f32 v152, v128, v129
  v_exp_f32 v133, v133
  v_cvt_pk_bf16_f32 v153, v130, v131
  v_mfma_f32_32x32x16_bf16 v[112:127], v[176:179], v[8:11], v[64:79]
  ds_read_b128 v[180:183], v254 offset:2048
  v_exp_f32 v134, v134
  v_exp_f32 v135, v135
  v_exp_f32 v136, v136
  v_cvt_pk_bf16_f32 v154, v132, v133
  v_exp_f32 v137, v137
  v_cvt_pk_bf16_f32 v155, v134, v135
  v_exp_f32 v138, v138
  v_exp_f32 v139, v139
  v_mfma_f32_32x32x16_bf16 v[32:47], v[168:171], v[152:155], v[32:47]
  v_exp_f32 v140, v140
  v_cvt_pk_bf16_f32 v156, v136, v137
  v_exp_f32 v141, v141
  v_cvt_pk_bf16_f32 v157, v138, v139
  v_exp_f32 v142, v142
  v_exp_f32 v143, v143
  v_cvt_pk_bf16_f32 v158, v140, v141
  v_cvt_pk_bf16_f32 v159, v142, v143
  v_mov_b32 v244, v254
  v_mov_b32 v245, v255
  v_add_u32 v254, 32768, v254
  v_add_u32 v255, 32768, v255
  s_add_u32 s38, s38, 1
  s_cmp_lg_u32 s38, 4
  s_cbranch_scc1 La_loop
La_post:
  s_nop 1
  v_mfma_f32_32x32x16_bf16 v[32:47], v[172:175], v[156:159], v[32:47]
  s_waitcnt lgkmcnt(0)
  s_nop 15
  v_mov_b32 v246, 0x5f800000
  v_cmp_lt_f32 vcc, v24, v246
  v_cmp_lt_f32 s[58:59], v40, v246
  s_nop 4
  s_and_b64 s[58:59], s[58:59], vcc
  s_cmp_eq_u64 s[58:59], -1
  s_cselect_b32 s64, 0, 1
  s_cmp_lg_u32 s73, 0
  s_cselect_b32 s64, 0, s64
  s_lshl_b32 s65, s3, 2
  s_add_u32 s65, s65, 98304
  v_mov_b32 v250, s65
  v_mov_b32 v251, s64
  ds_write_b32 v250, v251
  s_mul_i32 s65, s3, 2560
  s_add_u32 s65, s65, 99328
  v_add_u32 v250, s65, v247
  v_lshrrev_b32 v251, 2, v247
  v_add_u32 v251, s65, v251
  s_cmp_eq_u32 s70, 0
  s_cbranch_scc0 La_sendq0
  ds_write_b128 v250, v[32:35]
  ds_write_b128 v250, v[36:39] offset:1024
  ds_write_b32 v251, v40 offset:2048
  s_branch La_sent
La_sendq0:
  ds_write_b128 v250, v[16:19]
  ds_write_b128 v250, v[20:23] offset:1024
  ds_write_b32 v251, v24 offset:2048
  v_mov_b32 v16, v32
  v_mov_b32 v17, v33
  v_mov_b32 v18, v34
  v_mov_b32 v19, v35
  v_mov_b32 v20, v36
  v_mov_b32 v21, v37
  v_mov_b32 v22, v38
  v_mov_b32 v23, v39
  v_mov_b32 v24, v40
La_sent:
  s_waitcnt vmcnt(0) lgkmcnt(0)
  s_barrier
  v_and_b32 v252, 7, v1
  v_lshlrev_b32 v252, 2, v252
  v_add_u32 v252, 98304, v252
  ds_read_b32 v252, v252
  s_xor_b32 s64, s3, 4
  s_mul_i32 s65, s64, 2560
  s_add_u32 s65, s65, 99328
  v_add_u32 v250, s65, v247
  v_lshrrev_b32 v251, 2, v247
  v_add_u32 v251, s65, v251
  ds_read_b128 v[80:83], v250
  ds_read_b128 v[84:87], v250 offset:1024
  ds_read_b32 v88, v251 offset:2048
  s_lshl_b32 s37, s3, 11
  s_add_u32 s37, s37, 131072
  s_waitcnt lgkmcnt(0)
  v_cmp_ne_u32 vcc, 0, v252
  s_nop 4
  s_cmp_eq_u64 vcc, 0
  s_cbranch_scc1 La_done
  s_barrier
  s_mov_b32 s73, 1
  s_add_u32 m0, s63, 131072
  s_add_u32 s66, s62, 65536
  buffer_load_dwordx4 v247, s[4:7], s66 offen sc1 lds
  s_add_u32 m0, s63, 139264
  s_add_u32 s66, s62, 73728
  buffer_load_dwordx4 v247, s[4:7], s66 offen sc1 lds
  s_add_u32 m0, s63, 147456
  s_add_u32 s66, s62, 131072
  buffer_load_dwordx4 v247, s[4:7], s66 offen sc1 lds
  s_add_u32 m0, s63, 155648
  s_add_u32 s66, s62, 139264
  buffer_load_dwordx4 v247, s[4:7], s66 offen sc1 lds
  s_add_u32 m0, s63, 0
  s_add_u32 s66, s62, 81920
  buffer_load_dwordx4 v247, s[4:7], s66 offen sc1 lds
  s_add_u32 m0, s63, 8192
  s_add_u32 s66, s62, 90112
  buffer_load_dwordx4 v247, s[4:7], s66 offen sc1 lds
  s_add_u32 m0, s63, 16384
  s_add_u32 s66, s62, 147456
  buffer_load_dwordx4 v247, s[4:7], s66 offen sc1 lds
  s_add_u32 m0, s63, 24576
  s_add_u32 s66, s62, 155648
  buffer_load_dwordx4 v247, s[4:7], s66 offen sc1 lds
  s_waitcnt vmcnt(0)
  s_barrier
  v_mov_b32 v248, 0xff800000
  v_mov_b32 v249, 0xff800000
  s_mov_b32 s38, 0
La_fb:
  s_bfe_u32 s64, s38, 0x20003
  s_sub_u32 s65, s64, 1
  s_lshl_b32 s65, s65, 15
  s_cmp_eq_u32 s64, 0
  s_cselect_b32 s65, 131072, s65
  s_lshr_b32 s64, s38, 5
  s_lshl_b32 s64, s64, 14
  s_add_u32 s65, s65, s64
  s_and_b32 s64, s38, 7
  s_lshl_b32 s64, s64, 11
  s_add_u32 s65, s65, s64
  v_add_u32 v250, s65, v247
  ds_read_b128 v[176:179], v250
  s_waitcnt lgkmcnt(0)
  v_mfma_f32_32x32x16_bf16 v[80:95], v[176:179], v[4:7], 0
  v_mfma_f32_32x32x16_bf16 v[112:127], v[176:179], v[8:11], 0
  s_nop 15
  v_max3_f32 v248, v80, v81, v248
  v_max3_f32 v248, v82, v83, v248
  v_max3_f32 v248, v84, v85, v248
  v_max3_f32 v248, v86, v87, v248
  v_max3_f32 v248, v88, v89, v248
  v_max3_f32 v248, v90, v91, v248
  v_max3_f32 v248, v92, v93, v248
  v_max3_f32 v248, v94, v95, v248
  v_max3_f32 v249, v112, v113, v249
  v_max3_f32 v249, v114, v115, v249
  v_max3_f32 v249, v116, v117, v249
  v_max3_f32 v249, v118, v119, v249
  v_max3_f32 v249, v120, v121, v249
  v_max3_f32 v249, v122, v123, v249
  v_max3_f32 v249, v124, v125, v249
  v_max3_f32 v249, v126, v127, v249
  s_add_u32 s38, s38, 1
  s_cmp_lg_u32 s38, 64
  s_cbranch_scc1 La_fb
  v_add_u32 v254, s71, v247
  v_add_u32 v255, s71, v3
  v_add_u32 v244, s72, v247
  v_add_u32 v245, s72, v3
  s_branch La_main
La_done:
  s_cmp_eq_u32 s73, 0
  s_cbranch_scc1 La_bok
  s_barrier
  s_add_u32 m0, s63, 0
  s_add_u32 s66, s42, 0
  buffer_load_dwordx4 v0, s[8:11], s66 offen lds
  s_add_u32 m0, s63, 8192
  s_add_u32 s66, s42, 65536
  buffer_load_dwordx4 v0, s[8:11], s66 offen lds
  s_add_u32 m0, s63, 16384
  s_add_u32 s66, s42, 131072
  buffer_load_dwordx4 v0, s[8:11], s66 offen lds
  s_add_u32 m0, s63, 24576
  s_add_u32 s66, s42, 196608
  buffer_load_dwordx4 v0, s[8:11], s66 offen lds
  s_cmp_lt_u32 s3, 4
  s_cbranch_scc1 La_brl
  s_sub_u32 s51, s3, 4
  s_lshl_b32 s51, s51, 10
  s_lshl_b32 s50, s31, 14
  s_add_u32 s50, s50, s51
  s_sub_u32 s50, s50, 16384
  s_add_u32 m0, s51, 131072
  s_add_u32 s54, s50, 0
  s_max_i32 s54, s54, 0
  s_add_u32 s54, s54, s36
  s_add_u32 s54, s54, 65536
  buffer_load_dwordx4 v247, s[4:7], s54 offen sc1 lds
  s_add_u32 m0, s51, 135168
  s_add_u32 s54, s50, 4096
  s_max_i32 s54, s54, 0
  s_add_u32 s54, s54, s36
  s_add_u32 s54, s54, 65536
  buffer_load_dwordx4 v247, s[4:7], s54 offen sc1 lds
  s_add_u32 m0, s51, 139264
  s_add_u32 s54, s50, 8192
  s_max_i32 s54, s54, 0
  s_add_u32 s54, s54, s36
  s_add_u32 s54, s54, 65536
  buffer_load_dwordx4 v247, s[4:7], s54 offen sc1 lds
  s_add_u32 m0, s51, 143360
  s_add_u32 s54, s50, 12288
  s_max_i32 s54, s54, 0
  s_add_u32 s54, s54, s36
  s_add_u32 s54, s54, 65536
  buffer_load_dwordx4 v247, s[4:7], s54 offen sc1 lds
  s_add_u32 m0, s51, 147456
  s_add_u32 s54, s50, 16384
  s_max_i32 s54, s54, 0
  s_add_u32 s54, s54, s36
  s_add_u32 s54, s54, 65536
  buffer_load_dwordx4 v247, s[4:7], s54 offen sc1 lds
  s_add_u32 m0, s51, 151552
  s_add_u32 s54, s50, 20480
  s_max_i32 s54, s54, 0
  s_add_u32 s54, s54, s36
  s_add_u32 s54, s54, 65536
  buffer_load_dwordx4 v247, s[4:7], s54 offen sc1 lds
  s_add_u32 m0, s51, 155648
  s_add_u32 s54, s50, 24576
  s_max_i32 s54, s54, 0
  s_add_u32 s54, s54, s36
  s_add_u32 s54, s54, 65536
  buffer_load_dwordx4 v247, s[4:7], s54 offen sc1 lds
  s_add_u32 m0, s51, 159744
  s_add_u32 s54, s50, 28672
  s_max_i32 s54, s54, 0
  s_add_u32 s54, s54, s36
  s_add_u32 s54, s54, 65536
  buffer_load_dwordx4 v247, s[4:7], s54 offen sc1 lds
  s_lshl_b32 s50, s31, 13
  s_add_u32 s50, s50, s36
  s_add_u32 s50, s50, s51
  s_add_u32 m0, s51, 122880
  s_add_u32 s54, s50, 0
  buffer_load_dwordx4 v247, s[4:7], s54 offen sc1 lds
  s_add_u32 m0, s51, 126976
  s_add_u32 s54, s50, 4096
  buffer_load_dwordx4 v247, s[4:7], s54 offen sc1 lds
La_brl:
  s_waitcnt vmcnt(0)
  s_barrier
La_bok:
  v_add_u32 v244, s37, v247
  v_add_u32 v245, s37, v3
  s_lshl_b32 s64, s3, 10
  s_add_u32 s64, s64, 122880
  v_add_u32 v250, s64, v247
  ds_read_b128 v[12:15], v250
  ds_read_b128 v[208:211], v244 offset:16384
  ds_read_b128 v[204:207], v244 offset:14336
  ds_read_b128 v[200:203], v244 offset:12288
  ds_read_b128 v[196:199], v244 offset:10240
  ds_read_b128 v[192:195], v244 offset:8192
  ds_read_b128 v[188:191], v244 offset:6144
  ds_read_b128 v[184:187], v244 offset:4096
  ds_read_b128 v[180:183], v244 offset:2048
  ds_read_b128 v[176:179], v244 offset:0
  v_add_f32 v16, v16, v80
  v_add_f32 v17, v17, v81
  v_add_f32 v18, v18, v82
  v_add_f32 v19, v19, v83
  v_add_f32 v20, v20, v84
  v_add_f32 v21, v21, v85
  v_add_f32 v22, v22, v86
  v_add_f32 v23, v23, v87
  v_add_f32 v24, v24, v88
  s_and_b32 s64, s3, 3
  s_lshl_b32 s64, s64, 1
  s_add_u32 s64, s64, s70
  s_lshl_b32 s65, s31, 3
  s_add_u32 s64, s64, s65
  s_lshl_b32 s64, s64, 10
  s_lshl_b32 s68, s30, 16
  s_add_u32 s68, s68, s64
  s_add_u32 s68, s68, 12582912
  s_waitcnt lgkmcnt(6)
  v_mfma_f32_32x32x16_bf16 v[80:95], v[208:211], v[12:15], v[212:227]
  v_mfma_f32_32x32x16_bf16 v[96:111], v[204:207], v[12:15], 0
  v_mfma_f32_32x32x16_bf16 v[112:127], v[200:203], v[12:15], 0
  v_rcp_f32 v246, v24
  s_nop 1
  v_mul_f32 v16, v16, v246
  v_mul_f32 v17, v17, v246
  v_mul_f32 v18, v18, v246
  v_mul_f32 v19, v19, v246
  v_mul_f32 v20, v20, v246
  v_mul_f32 v21, v21, v246
  v_mul_f32 v22, v22, v246
  v_mul_f32 v23, v23, v246
  v_cvt_pk_bf16_f32 v152, v16, v17
  v_cvt_pk_bf16_f32 v153, v18, v19
  v_cvt_pk_bf16_f32 v154, v20, v21
  v_cvt_pk_bf16_f32 v155, v22, v23
  buffer_store_dwordx4 v[152:155], v247, s[4:7], s68 offen sc1
  s_waitcnt lgkmcnt(0)
  s_barrier
  s_mov_b64 exec, s[40:41]
  ds_read_b128 v[160:163], v245 offset:16384
  ds_read_b128 v[164:167], v245 offset:16896
  s_mov_b64 exec, -1
  s_nop 0
  s_mov_b32 s38, s35
  v_max_f32 v248, v80, v81
  v_max3_f32 v248, v82, v83, v248
  v_max3_f32 v248, v84, v85, v248
  v_max3_f32 v248, v86, v87, v248
  v_max3_f32 v248, v88, v89, v248
  v_max3_f32 v248, v90, v91, v248
  v_max3_f32 v248, v92, v93, v248
  v_max3_f32 v248, v94, v95, v248
  s_cmp_eq_u32 s38, 0
  s_cbranch_scc1 Lb_p1_done
  s_sub_u32 s38, s38, 1
  v_mfma_f32_32x32x16_bf16 v[128:143], v[196:199], v[12:15], 0
  v_max3_f32 v248, v96, v97, v248
  v_max3_f32 v248, v98, v99, v248
  v_max3_f32 v248, v100, v101, v248
  v_max3_f32 v248, v102, v103, v248
  v_max3_f32 v248, v104, v105, v248
  v_max3_f32 v248, v106, v107, v248
  v_max3_f32 v248, v108, v109, v248
  v_max3_f32 v248, v110, v111, v248
  s_cmp_eq_u32 s38, 0
  s_cbranch_scc1 Lb_p1_done
  s_sub_u32 s38, s38, 1
  v_mfma_f32_32x32x16_bf16 v[80:95], v[192:195], v[12:15], 0
  v_max3_f32 v248, v112, v113, v248
  v_max3_f32 v248, v114, v115, v248
  v_max3_f32 v248, v116, v117, v248
  v_max3_f32 v248, v118, v119, v248
  v_max3_f32 v248, v120, v121, v248
  v_max3_f32 v248, v122, v123, v248
  v_max3_f32 v248, v124, v125, v248
  v_max3_f32 v248, v126, v127, v248
  s_cmp_eq_u32 s38, 0
  s_cbranch_scc1 Lb_p1_done
  s_sub_u32 s38, s38, 1
  v_mfma_f32_32x32x16_bf16 v[96:111], v[188:191], v[12:15], 0
  v_max3_f32 v248, v128, v129, v248
  v_max3_f32 v248, v130, v131, v248
  v_max3_f32 v248, v132, v133, v248
  v_max3_f32 v248, v134, v135, v248
  v_max3_f32 v248, v136, v137, v248
  v_max3_f32 v248, v138, v139, v248
  v_max3_f32 v248, v140, v141, v248
  v_max3_f32 v248, v142, v143, v248
  s_cmp_eq_u32 s38, 0
  s_cbranch_scc1 Lb_p1_done
  s_sub_u32 s38, s38, 1
  v_mfma_f32_32x32x16_bf16 v[112:127], v[184:187], v[12:15], 0
  v_max3_f32 v248, v80, v81, v248
  v_max3_f32 v248, v82, v83, v248
  v_max3_f32 v248, v84, v85, v248
  v_max3_f32 v248, v86, v87, v248
  v_max3_f32 v248, v88, v89, v248
  v_max3_f32 v248, v90, v91, v248
  v_max3_f32 v248, v92, v93, v248
  v_max3_f32 v248, v94, v95, v248
  s_cmp_eq_u32 s38, 0
  s_cbranch_scc1 Lb_p1_done
  s_sub_u32 s38, s38, 1
  v_mfma_f32_32x32x16_bf16 v[128:143], v[180:183], v[12:15], 0
  v_max3_f32 v248, v96, v97, v248
  v_max3_f32 v248, v98, v99, v248
  v_max3_f32 v248, v100, v101, v248
  v_max3_f32 v248, v102, v103, v248
  v_max3_f32 v248, v104, v105, v248
  v_max3_f32 v248, v106, v107, v248
  v_max3_f32 v248, v108, v109, v248
  v_max3_f32 v248, v110, v111, v248
  s_cmp_eq_u32 s38, 0
  s_cbranch_scc1 Lb_p1_done
  s_sub_u32 s38, s38, 1
  v_mfma_f32_32x32x16_bf16 v[80:95], v[176:179], v[12:15], v[228:243]
  v_max3_f32 v248, v112, v113, v248
  v_max3_f32 v248, v114, v115, v248
  v_max3_f32 v248, v116, v117, v248
  v_max3_f32 v248, v118, v119, v248
  v_max3_f32 v248, v120, v121, v248
  v_max3_f32 v248, v122, v123, v248
  v_max3_f32 v248, v124, v125, v248
  v_max3_f32 v248, v126, v127, v248
  s_cmp_eq_u32 s38, 0
  s_cbranch_scc1 Lb_p1_done
  s_sub_u32 s38, s38, 1
  v_max3_f32 v248, v128, v129, v248
  v_max3_f32 v248, v130, v131, v248
  v_max3_f32 v248, v132, v133, v248
  v_max3_f32 v248, v134, v135, v248
  v_max3_f32 v248, v136, v137, v248
  v_max3_f32 v248, v138, v139, v248
  v_max3_f32 v248, v140, v141, v248
  v_max3_f32 v248, v142, v143, v248
  s_cmp_eq_u32 s38, 0
  s_cbranch_scc1 Lb_p1_done
  s_sub_u32 s38, s38, 1
  v_max3_f32 v248, v80, v81, v248
  v_max3_f32 v248, v82, v83, v248
  v_max3_f32 v248, v84, v85, v248
  v_max3_f32 v248, v86, v87, v248
  v_max3_f32 v248, v88, v89, v248
  v_max3_f32 v248, v90, v91, v248
  v_max3_f32 v248, v92, v93, v248
  v_max3_f32 v248, v94, v95, v248
Lb_p1_done:
  v_mov_b32 v246, v248
  s_nop 1
  v_permlane32_swap_b32 v248, v246
  s_nop 1
  v_max_f32 v248, v248, v246
  s_waitcnt vmcnt(0)
  s_lshl_b32 s56, s2, 3
  s_add_u32 s56, s56, s3
  s_lshl_b32 s56, s56, 7
  s_add_u32 s56, s56, 16908288
  v_mov_b32 v250, s56
  v_mov_b32 v251, s28
  s_mov_b64 exec, 1
  buffer_store_dword v251, v250, s[4:7], 0 offen sc1
  s_mov_b64 exec, -1
  s_mov_b32 s43, 0
  v_sub_f32 v212, v212, v248
  v_sub_f32 v213, v213, v248
  v_sub_f32 v214, v214, v248
  v_sub_f32 v215, v215, v248
  v_sub_f32 v216, v216, v248
  v_sub_f32 v217, v217, v248
  v_sub_f32 v218, v218, v248
  v_sub_f32 v219, v219, v248
  v_sub_f32 v220, v220, v248
  v_sub_f32 v221, v221, v248
  v_sub_f32 v222, v222, v248
  v_sub_f32 v223, v223, v248
  v_sub_f32 v224, v224, v248
  v_sub_f32 v225, v225, v248
  v_sub_f32 v226, v226, v248
  v_sub_f32 v227, v227, v248
  s_nop 1
  v_mfma_f32_32x32x16_bf16 v[80:95], v[208:211], v[12:15], v[212:227]
  v_sub_f32 v48, 0, v248
  v_sub_f32 v228, v228, v248
  v_mov_b32 v16, 0
  v_sub_f32 v49, 0, v248
  v_sub_f32 v229, v229, v248
  v_mov_b32 v17, 0
  v_sub_f32 v50, 0, v248
  v_sub_f32 v230, v230, v248
  v_mov_b32 v18, 0
  v_sub_f32 v51, 0, v248
  v_sub_f32 v231, v231, v248
  v_mov_b32 v19, 0
  v_sub_f32 v52, 0, v248
  v_sub_f32 v232, v232, v248
  v_mov_b32 v20, 0
  v_sub_f32 v53, 0, v248
  v_sub_f32 v233, v233, v248
  v_mov_b32 v21, 0
  v_sub_f32 v54, 0, v248
  v_sub_f32 v234, v234, v248
  v_mov_b32 v22, 0
  v_sub_f32 v55, 0, v248
  v_sub_f32 v235, v235, v248
  v_mov_b32 v23, 0
  v_sub_f32 v56, 0, v248
  v_sub_f32 v236, v236, v248
  v_mov_b32 v24, 0
  v_sub_f32 v57, 0, v248
  v_sub_f32 v237, v237, v248
  v_mov_b32 v25, 0
  v_sub_f32 v58, 0, v248
  v_sub_f32 v238, v238, v248
  v_mov_b32 v26, 0
  v_sub_f32 v59, 0, v248
  v_sub_f32 v239, v239, v248
  v_mov_b32 v27, 0
  v_sub_f32 v60, 0, v248
  v_sub_f32 v240, v240, v248
  v_mov_b32 v28, 0
  v_sub_f32 v61, 0, v248
  v_sub_f32 v241, v241, v248
  v_mov_b32 v29, 0
  v_sub_f32 v62, 0, v248
  v_sub_f32 v242, v242, v248
  v_mov_b32 v30, 0
  v_sub_f32 v63, 0, v248
  v_sub_f32 v243, v243, v248
  v_mov_b32 v31, 0
  s_lshr_b32 s52, s3, 2
  s_and_b32 s53, s3, 1
  s_bfe_u32 s54, s3, 0x10001
  s_lshl_b32 s55, s75, 1
  s_add_u32 s55, s55, s53
  s_lshl_b32 s56, s53, 2
  s_add_u32 s56, s56, s75
  s_cmp_eq_u32 s52, 0
  s_cselect_b32 s56, s56, s55
  s_lshl_b32 s57, s31, 5
  s_lshl_b32 s58, s54, 4
  s_add_u32 s57, s57, s58
  s_lshl_b32 s57, s57, 3
  s_add_u32 s57, s57, s56
  s_lshl_b32 s57, s57, 7
  s_add_u32 s57, s57, 16908288
  v_and_b32 v252, 15, v1
  v_lshlrev_b32 v252, 10, v252
  v_add_u32 v252, s57, v252
  s_mov_b32 s44, 0
  s_add_u32 m0, s63, 32768
  s_add_u32 s66, s42, 262144
  buffer_load_dwordx4 v0, s[8:11], s66 offen lds
  s_add_u32 m0, s63, 40960
  s_add_u32 s66, s42, 327680
  buffer_load_dwordx4 v0, s[8:11], s66 offen lds
  s_add_u32 m0, s63, 49152
  s_add_u32 s66, s42, 393216
  buffer_load_dwordx4 v0, s[8:11], s66 offen lds
  s_add_u32 m0, s63, 57344
  s_add_u32 s66, s42, 458752
  buffer_load_dwordx4 v0, s[8:11], s66 offen lds
  s_mov_b32 s43, 1
  s_mov_b32 s38, s35
  v_exp_f32 v80, v80
  v_exp_f32 v81, v81
  s_mov_b64 exec, s[40:41]
  ds_read_b128 v[168:171], v245 offset:14336
  ds_read_b128 v[172:175], v245 offset:14848
  s_mov_b64 exec, -1
  v_exp_f32 v82, v82
  v_exp_f32 v83, v83
  v_cvt_pk_bf16_f32 v144, v80, v81
  v_exp_f32 v84, v84
  v_cvt_pk_bf16_f32 v145, v82, v83
  v_exp_f32 v85, v85
  v_mfma_f32_32x32x16_bf16 v[96:111], v[204:207], v[12:15], v[48:63]
  v_exp_f32 v86, v86
  v_exp_f32 v87, v87
  v_cvt_pk_bf16_f32 v146, v84, v85
  v_exp_f32 v88, v88
  v_cvt_pk_bf16_f32 v147, v86, v87
  v_exp_f32 v89, v89
  v_exp_f32 v90, v90
  s_waitcnt lgkmcnt(2)
  v_mfma_f32_32x32x16_bf16 v[16:31], v[160:163], v[144:147], v[16:31]
  v_exp_f32 v91, v91
  v_cvt_pk_bf16_f32 v148, v88, v89
  v_exp_f32 v92, v92
  v_cvt_pk_bf16_f32 v149, v90, v91
  v_exp_f32 v93, v93
  v_exp_f32 v94, v94
  v_exp_f32 v95, v95
  v_cvt_pk_bf16_f32 v150, v92, v93
  v_cvt_pk_bf16_f32 v151, v94, v95
  s_nop 1
  v_mfma_f32_32x32x16_bf16 v[16:31], v[164:167], v[148:151], v[16:31]
  s_cmp_eq_u32 s38, 0
  s_cbranch_scc1 Lb_p2_done
  s_sub_u32 s38, s38, 1
  v_exp_f32 v96, v96
  v_exp_f32 v97, v97
  s_mov_b64 exec, s[40:41]
  ds_read_b128 v[160:163], v245 offset:12288
  ds_read_b128 v[164:167], v245 offset:12800
  s_mov_b64 exec, -1
  v_exp_f32 v98, v98
  v_exp_f32 v99, v99
  v_cvt_pk_bf16_f32 v144, v96, v97
  v_exp_f32 v100, v100
  v_cvt_pk_bf16_f32 v145, v98, v99
  v_exp_f32 v101, v101
  v_mfma_f32_32x32x16_bf16 v[80:95], v[200:203], v[12:15], v[48:63]
  v_exp_f32 v102, v102
  v_exp_f32 v103, v103
  v_cvt_pk_bf16_f32 v146, v100, v101
  v_exp_f32 v104, v104
  v_cvt_pk_bf16_f32 v147, v102, v103
  v_exp_f32 v105, v105
  v_exp_f32 v106, v106
  s_waitcnt lgkmcnt(2)
  v_mfma_f32_32x32x16_bf16 v[16:31], v[168:171], v[144:147], v[16:31]
  v_exp_f32 v107, v107
  v_cvt_pk_bf16_f32 v148, v104, v105
  v_exp_f32 v108, v108
  v_cvt_pk_bf16_f32 v149, v106, v107
  v_exp_f32 v109, v109
  v_exp_f32 v110, v110
  v_exp_f32 v111, v111
  v_cvt_pk_bf16_f32 v150, v108, v109
  v_cvt_pk_bf16_f32 v151, v110, v111
  s_nop 1
  v_mfma_f32_32x32x16_bf16 v[16:31], v[172:175], v[148:151], v[16:31]
  s_add_u32 m0, s63, 65536
  s_add_u32 s66, s42, 0
  buffer_load_dwordx4 v0, s[12:15], s66 offen lds
  s_add_u32 m0, s63, 73728
  s_add_u32 s66, s42, 65536
  buffer_load_dwordx4 v0, s[12:15], s66 offen lds
  s_add_u32 m0, s63, 81920
  s_add_u32 s66, s42, 131072
  buffer_load_dwordx4 v0, s[12:15], s66 offen lds
  s_add_u32 m0, s63, 90112
  s_add_u32 s66, s42, 196608
  buffer_load_dwordx4 v0, s[12:15], s66 offen lds
  s_mov_b32 s43, 2
  s_cmp_eq_u32 s38, 0
  s_cbranch_scc1 Lb_p2_done
  s_sub_u32 s38, s38, 1
  v_exp_f32 v80, v80
  v_exp_f32 v81, v81
  s_mov_b64 exec, s[40:41]
  ds_read_b128 v[168:171], v245 offset:10240
  ds_read_b128 v[172:175], v245 offset:10752
  s_mov_b64 exec, -1
  v_exp_f32 v82, v82
  v_exp_f32 v83, v83
  v_cvt_pk_bf16_f32 v144, v80, v81
  v_exp_f32 v84, v84
  v_cvt_pk_bf16_f32 v145, v82, v83
  v_exp_f32 v85, v85
  v_mfma_f32_32x32x16_bf16 v[96:111], v[196:199], v[12:15], v[48:63]
  v_exp_f32 v86, v86
  v_exp_f32 v87, v87
  v_cvt_pk_bf16_f32 v146, v84, v85
  v_exp_f32 v88, v88
  v_cvt_pk_bf16_f32 v147, v86, v87
  v_exp_f32 v89, v89
  v_exp_f32 v90, v90
  s_waitcnt lgkmcnt(2)
  v_mfma_f32_32x32x16_bf16 v[16:31], v[160:163], v[144:147], v[16:31]
  v_exp_f32 v91, v91
  v_cvt_pk_bf16_f32 v148, v88, v89
  v_exp_f32 v92, v92
  v_cvt_pk_bf16_f32 v149, v90, v91
  v_exp_f32 v93, v93
  v_exp_f32 v94, v94
  v_exp_f32 v95, v95
  v_cvt_pk_bf16_f32 v150, v92, v93
  v_cvt_pk_bf16_f32 v151, v94, v95
  s_nop 1
  v_mfma_f32_32x32x16_bf16 v[16:31], v[164:167], v[148:151], v[16:31]
  s_cmp_eq_u32 s38, 0
  s_cbranch_scc1 Lb_p2_done
  s_sub_u32 s38, s38, 1
  v_exp_f32 v96, v96
  v_exp_f32 v97, v97
  s_mov_b64 exec, s[40:41]
  ds_read_b128 v[160:163], v245 offset:8192
  ds_read_b128 v[164:167], v245 offset:8704
  s_mov_b64 exec, -1
  v_exp_f32 v98, v98
  v_exp_f32 v99, v99
  v_cvt_pk_bf16_f32 v144, v96, v97
  v_exp_f32 v100, v100
  v_cvt_pk_bf16_f32 v145, v98, v99
  v_exp_f32 v101, v101
  v_mfma_f32_32x32x16_bf16 v[80:95], v[192:195], v[12:15], v[48:63]
  v_exp_f32 v102, v102
  v_exp_f32 v103, v103
  v_cvt_pk_bf16_f32 v146, v100, v101
  v_exp_f32 v104, v104
  v_cvt_pk_bf16_f32 v147, v102, v103
  v_exp_f32 v105, v105
  v_exp_f32 v106, v106
  s_waitcnt lgkmcnt(2)
  v_mfma_f32_32x32x16_bf16 v[16:31], v[168:171], v[144:147], v[16:31]
  v_exp_f32 v107, v107
  v_cvt_pk_bf16_f32 v148, v104, v105
  v_exp_f32 v108, v108
  v_cvt_pk_bf16_f32 v149, v106, v107
  v_exp_f32 v109, v109
  v_exp_f32 v110, v110
  v_exp_f32 v111, v111
  v_cvt_pk_bf16_f32 v150, v108, v109
  v_cvt_pk_bf16_f32 v151, v110, v111
  s_nop 1
  v_mfma_f32_32x32x16_bf16 v[16:31], v[172:175], v[148:151], v[16:31]
  s_add_u32 m0, s63, 98304
  s_add_u32 s66, s42, 262144
  buffer_load_dwordx4 v0, s[12:15], s66 offen lds
  s_add_u32 m0, s63, 106496
  s_add_u32 s66, s42, 327680
  buffer_load_dwordx4 v0, s[12:15], s66 offen lds
  s_add_u32 m0, s63, 114688
  s_add_u32 s66, s42, 393216
  buffer_load_dwordx4 v0, s[12:15], s66 offen lds
  s_add_u32 m0, s63, 122880
  s_add_u32 s66, s42, 458752
  buffer_load_dwordx4 v0, s[12:15], s66 offen lds
  s_mov_b32 s43, 3
  s_cmp_eq_u32 s38, 0
  s_cbranch_scc1 Lb_p2_done
  s_sub_u32 s38, s38, 1
  v_exp_f32 v80, v80
  v_exp_f32 v81, v81
  s_mov_b64 exec, s[40:41]
  ds_read_b128 v[168:171], v245 offset:6144
  ds_read_b128 v[172:175], v245 offset:6656
  s_mov_b64 exec, -1
  v_exp_f32 v82, v82
  v_exp_f32 v83, v83
  v_cvt_pk_bf16_f32 v144, v80, v81
  v_exp_f32 v84, v84
  v_cvt_pk_bf16_f32 v145, v82, v83
  v_exp_f32 v85, v85
  v_mfma_f32_32x32x16_bf16 v[96:111], v[188:191], v[12:15], v[48:63]
  v_exp_f32 v86, v86
  v_exp_f32 v87, v87
  v_cvt_pk_bf16_f32 v146, v84, v85
  v_exp_f32 v88, v88
  v_cvt_pk_bf16_f32 v147, v86, v87
  v_exp_f32 v89, v89
  v_exp_f32 v90, v90
  s_waitcnt lgkmcnt(2)
  v_mfma_f32_32x32x16_bf16 v[16:31], v[160:163], v[144:147], v[16:31]
  v_exp_f32 v91, v91
  v_cvt_pk_bf16_f32 v148, v88, v89
  v_exp_f32 v92, v92
  v_cvt_pk_bf16_f32 v149, v90, v91
  v_exp_f32 v93, v93
  v_exp_f32 v94, v94
  v_exp_f32 v95, v95
  v_cvt_pk_bf16_f32 v150, v92, v93
  v_cvt_pk_bf16_f32 v151, v94, v95
  s_nop 1
  v_mfma_f32_32x32x16_bf16 v[16:31], v[164:167], v[148:151], v[16:31]
  s_cmp_eq_u32 s38, 0
  s_cbranch_scc1 Lb_p2_done
  s_sub_u32 s38, s38, 1
  v_exp_f32 v96, v96
  v_exp_f32 v97, v97
  s_mov_b64 exec, s[40:41]
  ds_read_b128 v[160:163], v245 offset:4096
  ds_read_b128 v[164:167], v245 offset:4608
  s_mov_b64 exec, -1
  v_exp_f32 v98, v98
  v_exp_f32 v99, v99
  v_cvt_pk_bf16_f32 v144, v96, v97
  v_exp_f32 v100, v100
  v_cvt_pk_bf16_f32 v145, v98, v99
  v_exp_f32 v101, v101
  v_mfma_f32_32x32x16_bf16 v[80:95], v[184:187], v[12:15], v[48:63]
  v_exp_f32 v102, v102
  v_exp_f32 v103, v103
  v_cvt_pk_bf16_f32 v146, v100, v101
  v_exp_f32 v104, v104
  v_cvt_pk_bf16_f32 v147, v102, v103
  v_exp_f32 v105, v105
  v_exp_f32 v106, v106
  s_waitcnt lgkmcnt(2)
  v_mfma_f32_32x32x16_bf16 v[16:31], v[168:171], v[144:147], v[16:31]
  v_exp_f32 v107, v107
  v_cvt_pk_bf16_f32 v148, v104, v105
  v_exp_f32 v108, v108
  v_cvt_pk_bf16_f32 v149, v106, v107
  v_exp_f32 v109, v109
  v_exp_f32 v110, v110
  v_exp_f32 v111, v111
  v_cvt_pk_bf16_f32 v150, v108, v109
  v_cvt_pk_bf16_f32 v151, v110, v111
  s_nop 1
  v_mfma_f32_32x32x16_bf16 v[16:31], v[172:175], v[148:151], v[16:31]
  s_cmp_eq_u32 s38, 0
  s_cbranch_scc1 Lb_p2_done
  s_sub_u32 s38, s38, 1
  v_exp_f32 v80, v80
  v_exp_f32 v81, v81
  s_mov_b64 exec, s[40:41]
  ds_read_b128 v[168:171], v245 offset:2048
  ds_read_b128 v[172:175], v245 offset:2560
  s_mov_b64 exec, -1
  v_exp_f32 v82, v82
  v_exp_f32 v83, v83
  v_cvt_pk_bf16_f32 v144, v80, v81
  v_exp_f32 v84, v84
  v_cvt_pk_bf16_f32 v145, v82, v83
  v_exp_f32 v85, v85
  v_mfma_f32_32x32x16_bf16 v[96:111], v[180:183], v[12:15], v[48:63]
  v_exp_f32 v86, v86
  v_exp_f32 v87, v87
  v_cvt_pk_bf16_f32 v146, v84, v85
  v_exp_f32 v88, v88
  v_cvt_pk_bf16_f32 v147, v86, v87
  v_exp_f32 v89, v89
  v_exp_f32 v90, v90
  s_waitcnt lgkmcnt(2)
  v_mfma_f32_32x32x16_bf16 v[16:31], v[160:163], v[144:147], v[16:31]
  v_exp_f32 v91, v91
  v_cvt_pk_bf16_f32 v148, v88, v89
  v_exp_f32 v92, v92
  v_cvt_pk_bf16_f32 v149, v90, v91
  v_exp_f32 v93, v93
  v_exp_f32 v94, v94
  v_exp_f32 v95, v95
  v_cvt_pk_bf16_f32 v150, v92, v93
  v_cvt_pk_bf16_f32 v151, v94, v95
  s_nop 1
  v_mfma_f32_32x32x16_bf16 v[16:31], v[164:167], v[148:151], v[16:31]
  s_cmp_eq_u32 s38, 0
  s_cbranch_scc1 Lb_p2_done
  s_sub_u32 s38, s38, 1
  v_exp_f32 v96, v96
  v_exp_f32 v97, v97
  s_mov_b64 exec, s[40:41]
  ds_read_b128 v[160:163], v245 offset:0
  ds_read_b128 v[164:167], v245 offset:512
  s_mov_b64 exec, -1
  v_exp_f32 v98, v98
  v_exp_f32 v99, v99
  v_cvt_pk_bf16_f32 v144, v96, v97
  v_exp_f32 v100, v100
  v_cvt_pk_bf16_f32 v145, v98, v99
  v_exp_f32 v101, v101
  v_mfma_f32_32x32x16_bf16 v[80:95], v[176:179], v[12:15], v[228:243]
  v_exp_f32 v102, v102
  v_exp_f32 v103, v103
  v_cvt_pk_bf16_f32 v146, v100, v101
  v_exp_f32 v104, v104
  v_cvt_pk_bf16_f32 v147, v102, v103
  v_exp_f32 v105, v105
  v_exp_f32 v106, v106
  s_waitcnt lgkmcnt(2)
  v_mfma_f32_32x32x16_bf16 v[16:31], v[168:171], v[144:147], v[16:31]
  v_exp_f32 v107, v107
  v_cvt_pk_bf16_f32 v148, v104, v105
  v_exp_f32 v108, v108
  v_cvt_pk_bf16_f32 v149, v106, v107
  v_exp_f32 v109, v109
  v_exp_f32 v110, v110
  v_exp_f32 v111, v111
  v_cvt_pk_bf16_f32 v150, v108, v109
  v_cvt_pk_bf16_f32 v151, v110, v111
  s_nop 1
  v_mfma_f32_32x32x16_bf16 v[16:31], v[172:175], v[148:151], v[16:31]
  s_cmp_eq_u32 s38, 0
  s_cbranch_scc1 Lb_p2_done
  s_sub_u32 s38, s38, 1
  v_exp_f32 v80, v80
  v_exp_f32 v81, v81
  v_exp_f32 v82, v82
  v_exp_f32 v83, v83
  v_cvt_pk_bf16_f32 v144, v80, v81
  v_exp_f32 v84, v84
  v_cvt_pk_bf16_f32 v145, v82, v83
  v_exp_f32 v85, v85
  v_exp_f32 v86, v86
  v_exp_f32 v87, v87
  v_cvt_pk_bf16_f32 v146, v84, v85
  v_exp_f32 v88, v88
  v_cvt_pk_bf16_f32 v147, v86, v87
  v_exp_f32 v89, v89
  v_exp_f32 v90, v90
  s_waitcnt lgkmcnt(0)
  v_mfma_f32_32x32x16_bf16 v[16:31], v[160:163], v[144:147], v[16:31]
  v_exp_f32 v91, v91
  v_cvt_pk_bf16_f32 v148, v88, v89
  v_exp_f32 v92, v92
  v_cvt_pk_bf16_f32 v149, v90, v91
  v_exp_f32 v93, v93
  v_exp_f32 v94, v94
  v_exp_f32 v95, v95
  v_cvt_pk_bf16_f32 v150, v92, v93
  v_cvt_pk_bf16_f32 v151, v94, v95
  s_nop 1
  v_mfma_f32_32x32x16_bf16 v[16:31], v[164:167], v[148:151], v[16:31]
Lb_p2_done:
  s_cmp_ge_u32 s43, 2
  s_cbranch_scc1 Lb_g1
  s_add_u32 m0, s63, 65536
  s_add_u32 s66, s42, 0
  buffer_load_dwordx4 v0, s[12:15], s66 offen lds
  s_add_u32 m0, s63, 73728
  s_add_u32 s66, s42, 65536
  buffer_load_dwordx4 v0, s[12:15], s66 offen lds
  s_add_u32 m0, s63, 81920
  s_add_u32 s66, s42, 131072
  buffer_load_dwordx4 v0, s[12:15], s66 offen lds
  s_add_u32 m0, s63, 90112
  s_add_u32 s66, s42, 196608
  buffer_load_dwordx4 v0, s[12:15], s66 offen lds
Lb_g1:
  s_cmp_ge_u32 s43, 3
  s_cbranch_scc1 Lb_g2
  s_add_u32 m0, s63, 98304
  s_add_u32 s66, s42, 262144
  buffer_load_dwordx4 v0, s[12:15], s66 offen lds
  s_add_u32 m0, s63, 106496
  s_add_u32 s66, s42, 327680
  buffer_load_dwordx4 v0, s[12:15], s66 offen lds
  s_add_u32 m0, s63, 114688
  s_add_u32 s66, s42, 393216
  buffer_load_dwordx4 v0, s[12:15], s66 offen lds
  s_add_u32 m0, s63, 122880
  s_add_u32 s66, s42, 458752
  buffer_load_dwordx4 v0, s[12:15], s66 offen lds
Lb_g2:
  s_cmp_eq_u32 s44, 1
  s_cbranch_scc1 Lb_g3
  buffer_load_dword v253, v252, s[4:7], 0 offen sc1
Lb_g3:
  s_nop 15
  s_lshl_b32 s68, s30, 16
  s_lshl_b32 s69, s34, 10
  s_add_u32 s68, s68, s69
  s_add_u32 s68, s68, 14680064
  v_rcp_f32 v246, v24
  s_nop 1
  v_mul_f32 v16, v16, v246
  v_mul_f32 v17, v17, v246
  v_mul_f32 v18, v18, v246
  v_mul_f32 v19, v19, v246
  v_mul_f32 v20, v20, v246
  v_mul_f32 v21, v21, v246
  v_mul_f32 v22, v22, v246
  v_mul_f32 v23, v23, v246
  v_cvt_pk_bf16_f32 v152, v16, v17
  v_cvt_pk_bf16_f32 v153, v18, v19
  v_cvt_pk_bf16_f32 v154, v20, v21
  v_cvt_pk_bf16_f32 v155, v22, v23
  buffer_store_dwordx4 v[152:155], v247, s[4:7], s68 offen sc1
  s_lshl_b32 s59, s31, 3
  s_add_u32 s59, s59, s55
  s_lshl_b32 s60, s59, 10
  s_mul_i32 s61, s52, 2097152
  s_add_u32 s60, s60, s61
  s_add_u32 s60, s60, 12582912
  s_bfe_u32 s61, s2, 0x20003
  s_lshl_b32 s61, s61, 2
  v_lshrrev_b32 v250, 5, v1
  v_lshlrev_b32 v251, 2, v250
  v_bfe_u32 v246, v1, 2, 2
  v_add_u32 v251, v251, v246
  v_lshlrev_b32 v251, 7, v251
  v_bfe_u32 v246, v1, 4, 1
  v_lshlrev_b32 v246, 5, v246
  v_add_u32 v251, v251, v246
  v_and_b32 v246, 3, v1
  v_lshlrev_b32 v246, 3, v246
  v_add_u32 v251, v251, v246
  v_bfe_u32 v246, v1, 3, 1
  v_lshlrev_b32 v246, 6, v246
  s_lshl_b32 s62, s52, 16
  s_lshl_b32 s63, s54, 15
  s_add_u32 s62, s62, s63
  v_add_u32 v251, s62, v251
  v_add_u32 v244, v251, v246
  v_xor_b32 v246, 64, v246
  v_add_u32 v245, v251, v246
  v_and_b32 v254, 31, v1
  v_lshlrev_b32 v254, 11, v254
  v_lshlrev_b32 v250, 4, v250
  v_add_u32 v254, v254, v250
  s_lshl_b32 s63, s54, 20
  s_add_u32 s60, s60, s63
  s_waitcnt vmcnt(2)
  s_barrier
  ds_read_b64_tr_b16 v[80:81], v244 offset:0
  ds_read_b64_tr_b16 v[82:83], v244 offset:1024
  ds_read_b64_tr_b16 v[84:85], v245 offset:0
  ds_read_b64_tr_b16 v[86:87], v245 offset:1024
  ds_read_b64_tr_b16 v[88:89], v244 offset:2048
  ds_read_b64_tr_b16 v[90:91], v244 offset:3072
  ds_read_b64_tr_b16 v[92:93], v245 offset:2048
  ds_read_b64_tr_b16 v[94:95], v245 offset:3072
  ds_read_b64_tr_b16 v[96:97], v244 offset:4096
  ds_read_b64_tr_b16 v[98:99], v244 offset:5120
  ds_read_b64_tr_b16 v[100:101], v245 offset:4096
  ds_read_b64_tr_b16 v[102:103], v245 offset:5120
  s_waitcnt lgkmcnt(8)
  ds_read_b64_tr_b16 v[104:105], v244 offset:6144
  ds_read_b64_tr_b16 v[106:107], v244 offset:7168
  ds_read_b64_tr_b16 v[108:109], v245 offset:6144
  ds_read_b64_tr_b16 v[110:111], v245 offset:7168
  ds_read_b64_tr_b16 v[112:113], v244 offset:8192
  ds_read_b64_tr_b16 v[114:115], v244 offset:9216
  ds_read_b64_tr_b16 v[116:117], v245 offset:8192
  ds_read_b64_tr_b16 v[118:119], v245 offset:9216
  ds_read_b64_tr_b16 v[120:121], v244 offset:10240
  ds_read_b64_tr_b16 v[122:123], v244 offset:11264
  ds_read_b64_tr_b16 v[124:125], v245 offset:10240
  ds_read_b64_tr_b16 v[126:127], v245 offset:11264
  s_waitcnt lgkmcnt(8)
  ds_read_b64_tr_b16 v[128:129], v244 offset:12288
  ds_read_b64_tr_b16 v[130:131], v244 offset:13312
  ds_read_b64_tr_b16 v[132:133], v245 offset:12288
  ds_read_b64_tr_b16 v[134:135], v245 offset:13312
  ds_read_b64_tr_b16 v[136:137], v244 offset:14336
  ds_read_b64_tr_b16 v[138:139], v244 offset:15360
  ds_read_b64_tr_b16 v[140:141], v245 offset:14336
  ds_read_b64_tr_b16 v[142:143], v245 offset:15360
  ds_read_b64_tr_b16 v[144:145], v244 offset:16384
  ds_read_b64_tr_b16 v[146:147], v244 offset:17408
  ds_read_b64_tr_b16 v[148:149], v245 offset:16384
  ds_read_b64_tr_b16 v[150:151], v245 offset:17408
  s_waitcnt lgkmcnt(8)
  ds_read_b64_tr_b16 v[152:153], v244 offset:18432
  ds_read_b64_tr_b16 v[154:155], v244 offset:19456
  ds_read_b64_tr_b16 v[156:157], v245 offset:18432
  ds_read_b64_tr_b16 v[158:159], v245 offset:19456
  ds_read_b64_tr_b16 v[160:161], v244 offset:20480
  ds_read_b64_tr_b16 v[162:163], v244 offset:21504
  ds_read_b64_tr_b16 v[164:165], v245 offset:20480
  ds_read_b64_tr_b16 v[166:167], v245 offset:21504
  ds_read_b64_tr_b16 v[168:169], v244 offset:22528
  ds_read_b64_tr_b16 v[170:171], v244 offset:23552
  ds_read_b64_tr_b16 v[172:173], v245 offset:22528
  ds_read_b64_tr_b16 v[174:175], v245 offset:23552
  s_waitcnt lgkmcnt(8)
  ds_read_b64_tr_b16 v[176:177], v244 offset:24576
  ds_read_b64_tr_b16 v[178:179], v244 offset:25600
  ds_read_b64_tr_b16 v[180:181], v245 offset:24576
  ds_read_b64_tr_b16 v[182:183], v245 offset:25600
  ds_read_b64_tr_b16 v[184:185], v244 offset:26624
  ds_read_b64_tr_b16 v[186:187], v244 offset:27648
  ds_read_b64_tr_b16 v[188:189], v245 offset:26624
  ds_read_b64_tr_b16 v[190:191], v245 offset:27648
  ds_read_b64_tr_b16 v[192:193], v244 offset:28672
  ds_read_b64_tr_b16 v[194:195], v244 offset:29696
  ds_read_b64_tr_b16 v[196:197], v245 offset:28672
  ds_read_b64_tr_b16 v[198:199], v245 offset:29696
  s_waitcnt lgkmcnt(8)
  ds_read_b64_tr_b16 v[200:201], v244 offset:30720
  ds_read_b64_tr_b16 v[202:203], v244 offset:31744
  ds_read_b64_tr_b16 v[204:205], v245 offset:30720
  ds_read_b64_tr_b16 v[206:207], v245 offset:31744
  s_mov_b32 s67, 65536
  s_waitcnt vmcnt(1)
Lo_spin:
  v_cmp_eq_u32 vcc, s28, v253
  s_nop 4
  s_cmp_eq_u64 vcc, -1
  s_cbranch_scc1 Lo_got
  s_sleep 1
  buffer_load_dword v253, v252, s[4:7], 0 offen sc1
  s_waitcnt vmcnt(0)
  s_sub_u32 s67, s67, 1
  s_cmp_lg_u32 s67, 0
  s_cbranch_scc1 Lo_spin
Lo_got:
  s_mov_b32 s67, 65536
Lo_ld:
  s_add_u32 s64, s60, 0
  buffer_load_dwordx4 v[16:19], v247, s[4:7], s64 offen sc1
  s_add_u32 s64, s60, 65536
  buffer_load_dwordx4 v[20:23], v247, s[4:7], s64 offen sc1
  s_add_u32 s64, s60, 131072
  buffer_load_dwordx4 v[24:27], v247, s[4:7], s64 offen sc1
  s_add_u32 s64, s60, 196608
  buffer_load_dwordx4 v[28:31], v247, s[4:7], s64 offen sc1
  s_add_u32 s64, s60, 262144
  buffer_load_dwordx4 v[32:35], v247, s[4:7], s64 offen sc1
  s_add_u32 s64, s60, 327680
  buffer_load_dwordx4 v[36:39], v247, s[4:7], s64 offen sc1
  s_add_u32 s64, s60, 393216
  buffer_load_dwordx4 v[40:43], v247, s[4:7], s64 offen sc1
  s_add_u32 s64, s60, 458752
  buffer_load_dwordx4 v[44:47], v247, s[4:7], s64 offen sc1
  s_add_u32 s64, s60, 524288
  buffer_load_dwordx4 v[48:51], v247, s[4:7], s64 offen sc1
  s_add_u32 s64, s60, 589824
  buffer_load_dwordx4 v[52:55], v247, s[4:7], s64 offen sc1
  s_add_u32 s64, s60, 655360
  buffer_load_dwordx4 v[56:59], v247, s[4:7], s64 offen sc1
  s_add_u32 s64, s60, 720896
  buffer_load_dwordx4 v[60:63], v247, s[4:7], s64 offen sc1
  s_add_u32 s64, s60, 786432
  buffer_load_dwordx4 v[64:67], v247, s[4:7], s64 offen sc1
  s_add_u32 s64, s60, 851968
  buffer_load_dwordx4 v[68:71], v247, s[4:7], s64 offen sc1
  s_add_u32 s64, s60, 917504
  buffer_load_dwordx4 v[72:75], v247, s[4:7], s64 offen sc1
  s_add_u32 s64, s60, 983040
  buffer_load_dwordx4 v[76:79], v247, s[4:7], s64 offen sc1
  s_cmp_eq_u32 s52, 0
  s_cbranch_scc1 Lo_rdy
  s_waitcnt vmcnt(0)
  v_max_u32 v253, v16, v17
  v_max3_u32 v253, v18, v19, v253
  v_max3_u32 v253, v20, v21, v253
  v_max3_u32 v253, v22, v23, v253
  v_max3_u32 v253, v24, v25, v253
  v_max3_u32 v253, v26, v27, v253
  v_max3_u32 v253, v28, v29, v253
  v_max3_u32 v253, v30, v31, v253
  v_max3_u32 v253, v32, v33, v253
  v_max3_u32 v253, v34, v35, v253
  v_max3_u32 v253, v36, v37, v253
  v_max3_u32 v253, v38, v39, v253
  v_max3_u32 v253, v40, v41, v253
  v_max3_u32 v253, v42, v43, v253
  v_max3_u32 v253, v44, v45, v253
  v_max3_u32 v253, v46, v47, v253
  v_max3_u32 v253, v48, v49, v253
  v_max3_u32 v253, v50, v51, v253
  v_max3_u32 v253, v52, v53, v253
  v_max3_u32 v253, v54, v55, v253
  v_max3_u32 v253, v56, v57, v253
  v_max3_u32 v253, v58, v59, v253
  v_max3_u32 v253, v60, v61, v253
  v_max3_u32 v253, v62, v63, v253
  v_max3_u32 v253, v64, v65, v253
  v_max3_u32 v253, v66, v67, v253
  v_max3_u32 v253, v68, v69, v253
  v_max3_u32 v253, v70, v71, v253
  v_max3_u32 v253, v72, v73, v253
  v_max3_u32 v253, v74, v75, v253
  v_max3_u32 v253, v76, v77, v253
  v_max3_u32 v253, v78, v79, v253
  v_cmp_eq_u32 vcc, -1, v253
  s_nop 4
  s_cmp_eq_u64 vcc, 0
  s_cbranch_scc1 Lo_rdy
  s_sub_u32 s67, s67, 1
  s_cmp_lg_u32 s67, 0
  s_cbranch_scc1 Lo_ld
Lo_rdy:
  s_waitcnt lgkmcnt(0)
  s_waitcnt vmcnt(15)
  v_mfma_f32_32x32x16_bf16 v[208:223], v[80:83], v[16:19], 0
  v_mfma_f32_32x32x16_bf16 v[224:239], v[84:87], v[16:19], 0
  s_waitcnt vmcnt(14)
  v_mfma_f32_32x32x16_bf16 v[208:223], v[88:91], v[20:23], v[208:223]
  v_mfma_f32_32x32x16_bf16 v[224:239], v[92:95], v[20:23], v[224:239]
  s_waitcnt vmcnt(13)
  v_mfma_f32_32x32x16_bf16 v[208:223], v[96:99], v[24:27], v[208:223]
  v_mfma_f32_32x32x16_bf16 v[224:239], v[100:103], v[24:27], v[224:239]
  s_waitcnt vmcnt(12)
  v_mfma_f32_32x32x16_bf16 v[208:223], v[104:107], v[28:31], v[208:223]
  v_mfma_f32_32x32x16_bf16 v[224:239], v[108:111], v[28:31], v[224:239]
  s_waitcnt vmcnt(11)
  v_mfma_f32_32x32x16_bf16 v[208:223], v[112:115], v[32:35], v[208:223]
  v_mfma_f32_32x32x16_bf16 v[224:239], v[116:119], v[32:35], v[224:239]
  s_waitcnt vmcnt(10)
  v_mfma_f32_32x32x16_bf16 v[208:223], v[120:123], v[36:39], v[208:223]
  v_mfma_f32_32x32x16_bf16 v[224:239], v[124:127], v[36:39], v[224:239]
  s_waitcnt vmcnt(9)
  v_mfma_f32_32x32x16_bf16 v[208:223], v[128:131], v[40:43], v[208:223]
  v_mfma_f32_32x32x16_bf16 v[224:239], v[132:135], v[40:43], v[224:239]
  s_waitcnt vmcnt(8)
  v_mfma_f32_32x32x16_bf16 v[208:223], v[136:139], v[44:47], v[208:223]
  v_mfma_f32_32x32x16_bf16 v[224:239], v[140:143], v[44:47], v[224:239]
  s_waitcnt vmcnt(7)
  v_mfma_f32_32x32x16_bf16 v[208:223], v[144:147], v[48:51], v[208:223]
  v_mfma_f32_32x32x16_bf16 v[224:239], v[148:151], v[48:51], v[224:239]
  s_waitcnt vmcnt(6)
  v_mfma_f32_32x32x16_bf16 v[208:223], v[152:155], v[52:55], v[208:223]
  v_mfma_f32_32x32x16_bf16 v[224:239], v[156:159], v[52:55], v[224:239]
  s_waitcnt vmcnt(5)
  v_mfma_f32_32x32x16_bf16 v[208:223], v[160:163], v[56:59], v[208:223]
  v_mfma_f32_32x32x16_bf16 v[224:239], v[164:167], v[56:59], v[224:239]
  s_waitcnt vmcnt(4)
  v_mfma_f32_32x32x16_bf16 v[208:223], v[168:171], v[60:63], v[208:223]
  v_mfma_f32_32x32x16_bf16 v[224:239], v[172:175], v[60:63], v[224:239]
  s_waitcnt vmcnt(3)
  v_mfma_f32_32x32x16_bf16 v[208:223], v[176:179], v[64:67], v[208:223]
  v_mfma_f32_32x32x16_bf16 v[224:239], v[180:183], v[64:67], v[224:239]
  s_waitcnt vmcnt(2)
  v_mfma_f32_32x32x16_bf16 v[208:223], v[184:187], v[68:71], v[208:223]
  v_mfma_f32_32x32x16_bf16 v[224:239], v[188:191], v[68:71], v[224:239]
  s_waitcnt vmcnt(1)
  v_mfma_f32_32x32x16_bf16 v[208:223], v[192:195], v[72:75], v[208:223]
  v_mfma_f32_32x32x16_bf16 v[224:239], v[196:199], v[72:75], v[224:239]
  s_waitcnt vmcnt(0)
  v_mfma_f32_32x32x16_bf16 v[208:223], v[200:203], v[76:79], v[208:223]
  v_mfma_f32_32x32x16_bf16 v[224:239], v[204:207], v[76:79], v[224:239]
  s_lshl_b32 s64, s3, 12
  s_add_u32 s64, s64, 131072
  v_add_u32 v250, s64, v247
  s_xor_b32 s65, s3, 2
  s_lshl_b32 s65, s65, 12
  s_add_u32 s65, s65, 131072
  v_add_u32 v251, s65, v247
  s_nop 15
  s_cmp_eq_u32 s54, 0
  s_cbranch_scc0 Lo_send0
  ds_write_b128 v250, v[224:227] offset:0
  ds_write_b128 v250, v[228:231] offset:1024
  ds_write_b128 v250, v[232:235] offset:2048
  ds_write_b128 v250, v[236:239] offset:3072
  s_branch Lo_sent
Lo_send0:
  ds_write_b128 v250, v[208:211] offset:0
  ds_write_b128 v250, v[212:215] offset:1024
  ds_write_b128 v250, v[216:219] offset:2048
  ds_write_b128 v250, v[220:223] offset:3072
  v_mov_b32 v208, v224
  v_mov_b32 v209, v225
  v_mov_b32 v210, v226
  v_mov_b32 v211, v227
  v_mov_b32 v212, v228
  v_mov_b32 v213, v229
  v_mov_b32 v214, v230
  v_mov_b32 v215, v231
  v_mov_b32 v216, v232
  v_mov_b32 v217, v233
  v_mov_b32 v218, v234
  v_mov_b32 v219, v235
  v_mov_b32 v220, v236
  v_mov_b32 v221, v237
  v_mov_b32 v222, v238
  v_mov_b32 v223, v239
Lo_sent:
  s_waitcnt lgkmcnt(0)
  s_barrier
  ds_read_b128 v[16:19], v251 offset:0
  ds_read_b128 v[20:23], v251 offset:1024
  ds_read_b128 v[24:27], v251 offset:2048
  ds_read_b128 v[28:31], v251 offset:3072
  s_lshl_b32 s64, s59, 16
  s_lshl_b32 s65, s52, 10
  s_add_u32 s64, s64, s65
  s_lshl_b32 s65, s39, 7
  s_add_u32 s64, s64, s65
  s_lshl_b32 s65, s54, 6
  s_add_u32 s64, s64, s65
  s_waitcnt lgkmcnt(0)
  v_add_f32 v208, v208, v16
  v_add_f32 v209, v209, v17
  v_add_f32 v210, v210, v18
  v_add_f32 v211, v211, v19
  v_add_f32 v212, v212, v20
  v_add_f32 v213, v213, v21
  v_add_f32 v214, v214, v22
  v_add_f32 v215, v215, v23
  v_add_f32 v216, v216, v24
  v_add_f32 v217, v217, v25
  v_add_f32 v218, v218, v26
  v_add_f32 v219, v219, v27
  v_add_f32 v220, v220, v28
  v_add_f32 v221, v221, v29
  v_add_f32 v222, v222, v30
  v_add_f32 v223, v223, v31
  v_cvt_pk_bf16_f32 v112, v208, v209
  v_cvt_pk_bf16_f32 v113, v210, v211
  v_cvt_pk_bf16_f32 v114, v212, v213
  v_cvt_pk_bf16_f32 v115, v214, v215
  s_nop 1
  v_permlane32_swap_b32 v112, v114
  v_permlane32_swap_b32 v113, v115
  s_nop 1
  buffer_store_dwordx4 v[112:115], v254, s[16:19], s64 offen offset:0
  v_cvt_pk_bf16_f32 v116, v216, v217
  v_cvt_pk_bf16_f32 v117, v218, v219
  v_cvt_pk_bf16_f32 v118, v220, v221
  v_cvt_pk_bf16_f32 v119, v222, v223
  s_nop 1
  v_permlane32_swap_b32 v116, v118
  v_permlane32_swap_b32 v117, v119
  s_nop 1
  buffer_store_dwordx4 v[116:119], v254, s[16:19], s64 offen offset:32
Lfa_end:
  s_endpgm
.section .rodata,"a"
.p2align 6
.amdhsa_kernel concat_heads__softmax_full_mha__sliding_block__prompt_kernel
  .amdhsa_next_free_vgpr 256
  .amdhsa_next_free_sgpr 102
  .amdhsa_accum_offset 256
  .amdhsa_group_segment_fixed_size 0
  .amdhsa_kernarg_size 72
  .amdhsa_user_sgpr_count 2
  .amdhsa_user_sgpr_kernarg_segment_ptr 1
  .amdhsa_system_sgpr_workgroup_id_x 1
.end_amdhsa_kernel
```
